```python
import torch

def _softmax(x, axis=-1):
    return torch.softmax(x, dim=axis)
def _gelu(x):
    return torch.nn.functional.gelu(x, approximate="tanh")
def _silu(x):
    return torch.nn.functional.silu(x)
def _sigmoid(x):
    return torch.sigmoid(x)
def _layernorm(x, axis=-1, eps=1e-5):
    m = x.mean(dim=axis, keepdim=True)
    v = x.var(dim=axis, keepdim=True, unbiased=False)
    return (x - m) / torch.sqrt(v + eps)
def _scatter_add(tgt, idx, src, axis=0):
    return tgt.clone().index_add_(axis, idx, src)
def _segment_sum(src, seg, n):
    out = torch.zeros((n,) + src.shape[1:], dtype=src.dtype)
    return out.index_add_(0, seg, src)
def _pad(x, pw):
    flat = tuple(v for pair in reversed(pw) for v in pair)
    return torch.nn.functional.pad(x, flat)

kernel_name = 'parallel_sum__ssm_conv_s4d__glu_gated_reglu__prompt'

def setup_inputs():

    _w = (lambda a: (lambda t: t.to(torch.bfloat16) if t.is_floating_point() else t)(torch.as_tensor(a)))
    def _A_setup():
        Bsz, L, D, N = 1, 2048, 448, 256
        return {
            "u": _w((lambda *s: torch.randn(*s, dtype=torch.bfloat16) * 0.05)(Bsz, L, D)),
            "log_A_real": _w((lambda *s: torch.randn(*s, dtype=torch.bfloat16) * 6.4)(D, N) * 0.5),
            "A_imag": _w((lambda *s: torch.randn(*s, dtype=torch.bfloat16) * 0.05)(D, N) * 3.14),
            "C_real": _w((lambda *s: torch.randn(*s, dtype=torch.bfloat16) * 0.1)(D, N) / N ** 0.5),
            "C_imag": _w((lambda *s: torch.randn(*s, dtype=torch.bfloat16) * 0.1)(D, N) / N ** 0.5),
            "log_dt": _w((lambda *s: torch.randn(*s, dtype=torch.bfloat16) * 0.05)(D) * 0.5 - 4.0),
            "D_skip": _w((lambda *s: torch.randn(*s, dtype=torch.bfloat16) * 0.05)(D)),
        }
    _A_in = _A_setup()

    def _B_setup():
        B, S, D, F = 1, 2048, 448, 1792
        return {
            "x": _w((lambda *s: torch.randn(*s, dtype=torch.bfloat16) * 0.05)(B, S, D)),
            "W_gate": _w((lambda *s: torch.randn(*s, dtype=torch.bfloat16) * 0.4)(D, F) * (2.0 / D) ** 0.5),
            "W_up": _w((lambda *s: torch.randn(*s, dtype=torch.bfloat16) * 0.4)(D, F) * (2.0 / D) ** 0.5),
            "W_down": _w((lambda *s: torch.randn(*s, dtype=torch.bfloat16) * 0.4)(F, D) * (1.0 / F) ** 0.5),
        }
    _B_in = _B_setup()

    return {
        "A_u": _A_in["u"],
        "A_log_A_real": _A_in["log_A_real"],
        "A_A_imag": _A_in["A_imag"],
        "A_C_real": _A_in["C_real"],
        "A_C_imag": _A_in["C_imag"],
        "A_log_dt": _A_in["log_dt"],
        "A_D_skip": _A_in["D_skip"],
        "B_x": _B_in["x"],
        "B_W_gate": _B_in["W_gate"],
        "B_W_up": _B_in["W_up"],
        "B_W_down": _B_in["W_down"],
    }

def reference(A_u, A_log_A_real, A_A_imag, A_C_real, A_C_imag, A_log_dt, A_D_skip, B_x, B_W_gate, B_W_up, B_W_down):
    def _A_ref(u, log_A_real, A_imag, C_real, C_imag, log_dt, D_skip):
        L = u.shape[1]
        dt = torch.exp(log_dt)
        A = -torch.exp(log_A_real) + 1j * A_imag
        C = (C_real + 1j * C_imag) * dt[:, None]
        pos = (lambda x, dt: x.to(dt))(torch.arange(L), log_dt.dtype)
        P = torch.exp((A * dt[:, None])[:, :, None] * pos[None, None, :])
        K = 2.0 * torch.einsum("dn,dnl->dl", C, P).real
        L2 = 2 * L
        u_t = (lambda x, *d: x.permute(*d))(u, 0, 2, 1)
        Kf = (lambda x, *a, **k: torch.fft.rfft(x.float(), *a, **k))(K, L2)
        Uf = (lambda x, *a, **k: torch.fft.rfft(x.float(), *a, **k))(u_t, L2)
        y = (lambda x, *a, **k: torch.fft.irfft(x, *a, **k).to(torch.bfloat16))(Uf * Kf[None, :, :], L2)[:, :, :L]
        y = (lambda x, *d: x.permute(*d))(y, 0, 2, 1)
        return y + u * D_skip[None, None, :]

    def _B_ref(x, W_gate, W_up, W_down):
        gate = torch.einsum("bsd,df->bsf", x, W_gate)
        up = torch.einsum("bsd,df->bsf", x, W_up)
        gate = gate * (lambda x, dt: x.to(dt))(gate > 0, gate.dtype)
        h = gate * up
        return torch.einsum("bsf,fd->bsd", h, W_down)

    x = A_u
    xn = _layernorm(x, axis=-1)
    return x + _A_ref(xn, A_log_A_real, A_A_imag, A_C_real, A_C_imag, A_log_dt, A_D_skip) + _B_ref(xn, B_W_gate, B_W_up, B_W_down)
```

```asm
; @launch grid=(256,1,1) block=(512,1,1) lds=163840
.amdgcn_target "amdgcn-amd-amdhsa--gfx950"
.text
.globl parallel_sum__ssm_conv_s4d__glu_gated_reglu__prompt_kernel
.p2align 8
.type parallel_sum__ssm_conv_s4d__glu_gated_reglu__prompt_kernel,@function
parallel_sum__ssm_conv_s4d__glu_gated_reglu__prompt_kernel:
    s_cmp_ge_u32 s2, 256
    s_cbranch_scc1 L_end
    s_load_dwordx16 s[4:19], s[0:1], 0
    s_load_dwordx8 s[20:27], s[0:1], 64
    s_load_dwordx4 s[28:31], s[0:1], 96
    v_lshrrev_b32 v2, 6, v0
    v_and_b32 v1, 63, v0
    v_readfirstlane_b32 s3, v2
    s_and_b32 s52, s2, 7
    s_lshr_b32 s53, s2, 3
    s_getpc_b64 s[60:61]
L_pc:
    v_and_b32 v2, 0x1e0, v0
    v_add_u32 v2, s53, v2
    v_lshlrev_b32 v2, 7, v2
    v_min_u32 v2, L_end-L_pc, v2
    global_load_dword v95, v2, s[60:61]
    s_and_b32 s59, s52, 3
    s_lshr_b32 s60, s52, 2
    s_cmp_lt_u32 s53, 4
    s_cbranch_scc1 L_side
    s_sub_u32 s53, s53, 4
    s_and_b32 s61, s53, 3
    s_lshr_b32 s57, s53, 2
    s_lshl_b32 s54, s59, 2
    s_add_u32 s54, s54, s61
    s_mul_i32 s55, s60, 7
    s_add_u32 s55, s55, s57
    s_lshl_b32 s56, s59, 1
    s_add_u32 s56, s56, s60
    s_lshl_b32 s56, s56, 2
    s_add_u32 s56, s56, s61
    s_add_u32 s87, s61, s57
    s_and_b32 s87, s87, 1
    s_mul_i32 s58, s52, 28
    s_add_u32 s58, s58, s53
    s_lshl_b32 s58, s58, 1
    s_bfe_u32 s83, s3, 0x10001
    s_add_u32 s82, s58, s83
    s_lshr_b32 s59, s3, 2
    s_lshl_b32 s59, s59, 1
    s_and_b32 s60, s3, 1
    s_add_u32 s59, s59, s60
    s_lshl_b32 s59, s59, 7
    s_lshl_b32 s62, s82, 9
    s_add_u32 s59, s59, s62
    v_lshl_add_u32 v122, v1, 1, s59
    s_lshl_b32 s62, s58, 1
    s_and_b32 s64, s3, 3
    v_lshrrev_b32 v120, 4, v1
    v_mul_u32_u24 v200, 3584, v120
    v_bfe_u32 v121, v1, 2, 2
    v_xor_b32 v121, v121, v120
    v_lshl_add_u32 v200, v121, 6, v200
    v_and_b32 v121, 3, v1
    v_lshl_add_u32 v200, v121, 4, v200
    s_mul_i32 s59, s64, 28672
    s_lshl_b32 s61, s55, 8
    s_add_u32 s59, s59, s61
    v_add_u32 v200, s59, v200
    s_lshl_b32 s59, s60, 2
    v_add_u32 v120, s59, v120
    v_and_b32 v121, 7, v1
    v_xor_b32 v121, v121, v120
    v_lshrrev_b32 v120, 3, v1
    v_mul_u32_u24 v201, 896, v120
    v_lshl_add_u32 v201, v121, 4, v201
    s_lshl_b32 s59, s54, 4
    s_add_u32 s59, s59, s64
    s_mul_i32 s59, s59, 7168
    v_add_u32 v201, s59, v201
    s_lshl_b32 s69, s64, 11
    s_lshl_b32 s70, s64, 10
    s_lshl_b32 s74, s52, 2
    s_lshr_b32 s74, 0x0, s74
    s_and_b32 s74, s74, 15
    s_mul_i32 s75, s87, 4
    s_add_u32 s75, s75, s74
    s_sub_u32 s59, s75, 7
    s_cselect_b32 s75, s75, s59
    s_mul_i32 s71, s75, 229376
    s_add_u32 s72, s71, 14336
    s_lshl_b32 s73, s75, 7
    s_waitcnt lgkmcnt(0)
    s_mov_b32 s18, s74
    global_load_ushort v128, v122, s[6:7] nt
    global_load_ushort v129, v122, s[8:9] nt
    global_load_ushort v130, v122, s[10:11] nt
    global_load_ushort v131, v122, s[12:13] nt
    s_load_dword s63, s[14:15], s62
    s_barrier
    s_mov_b32 s36, s20
    s_and_b32 s37, s21, 0xffff
    s_mov_b32 s38, 1605632
    s_mov_b32 s39, 0x20000
    s_mov_b32 s40, s22
    s_and_b32 s41, s23, 0xffff
    s_mov_b32 s42, 1605632
    s_mov_b32 s43, 0x20000
    s_mov_b32 s32, s4
    s_and_b32 s33, s5, 0xffff
    s_mov_b32 s34, 1835008
    s_mov_b32 s35, 0x20000
    s_cmp_ge_u32 s3, 4
    s_cbranch_scc1 L_px1
    s_add_u32 m0, s69, 98304
    s_nop 0
    buffer_load_dwordx4 v200, s[36:39], s71 offen lds
    s_add_u32 m0, s69, 106496
    s_nop 0
    buffer_load_dwordx4 v200, s[40:43], s71 offen lds
    s_add_u32 m0, s69, 99328
    s_add_u32 s71, s71, 114688
    buffer_load_dwordx4 v200, s[36:39], s72 offen lds
    s_add_u32 m0, s69, 107520
    s_cmp_eq_u32 s71, 1605632
    buffer_load_dwordx4 v200, s[40:43], s72 offen lds
    s_cselect_b32 s71, 0, s71
    s_add_u32 s72, s71, 14336
    s_add_u32 m0, s70, 49152
    s_add_u32 s59, s73, 0
    s_nop 0
    buffer_load_dwordx4 v201, s[32:35], s59 offen lds
    s_add_u32 m0, s70, 53248
    s_add_u32 s59, s73, 28672
    buffer_load_dwordx4 v201, s[32:35], s59 offen lds
    s_add_u32 m0, s70, 57344
    s_add_u32 s59, s73, 57344
    buffer_load_dwordx4 v201, s[32:35], s59 offen lds
    s_add_u32 m0, s70, 61440
    s_add_u32 s59, s73, 86016
    buffer_load_dwordx4 v201, s[32:35], s59 offen lds
    s_add_u32 s73, s73, 128
    s_cmp_eq_u32 s73, 896
    s_cselect_b32 s73, 0, s73
    s_and_b32 s65, s3, 1
    s_lshr_b32 s66, s3, 1
    v_and_b32 v9, 31, v1
    s_lshl_b32 s59, s65, 13
    s_add_u32 s59, s59, 49152
    v_lshl_add_u32 v9, v9, 7, s59
    v_bfe_u32 v10, v1, 1, 3
    v_lshrrev_b32 v11, 5, v1
    v_xor_b32 v10, v10, v11
    v_xor_b32 v2, 0, v10
    v_lshl_add_u32 v2, v2, 4, v9
    v_xor_b32 v3, 2, v10
    v_lshl_add_u32 v3, v3, 4, v9
    v_xor_b32 v4, 4, v10
    v_lshl_add_u32 v4, v4, 4, v9
    v_xor_b32 v5, 6, v10
    v_lshl_add_u32 v5, v5, 4, v9
    v_lshrrev_b32 v9, 3, v1
    v_mul_u32_u24 v12, 896, v9
    v_lshrrev_b32 v9, 2, v1
    v_lshrrev_b32 v10, 4, v1
    v_xor_b32 v9, v9, v10
    v_and_b32 v9, 1, v9
    v_lshl_add_u32 v12, v9, 6, v12
    v_and_b32 v9, 3, v1
    v_lshl_add_u32 v12, v9, 4, v12
    s_and_b32 s76, s3, 3
    s_lshl_b32 s60, s57, 7
    s_mul_i32 s74, s76, 401408
    s_add_u32 s74, s74, s60
    s_add_u32 s74, s74, 200704
    s_sub_u32 s74, s74, 7168
    s_lshl_b32 s76, s76, 12
    s_mov_b32 s44, s24
    s_and_b32 s45, s25, 0xffff
    s_mov_b32 s46, 1605632
    s_mov_b32 s47, 0x20000
    v_bfe_u32 v8, v1, 4, 1
    v_lshlrev_b32 v8, 5, v8
    v_and_b32 v9, 3, v1
    v_lshl_add_u32 v8, v9, 3, v8
    v_bfe_u32 v10, v1, 2, 2
    v_lshl_add_u32 v14, v11, 2, v10
    v_lshl_add_u32 v14, v14, 7, s76
    v_add_u32 v14, v14, v8
    v_bfe_u32 v9, v1, 3, 1
    v_lshl_add_u32 v14, v9, 6, v14
    v_lshl_add_u32 v9, v11, 3, v10
    v_lshl_add_u32 v9, v9, 8, v8
    v_add_u32 v9, 98304, v9
    v_xor_b32 v10, s3, v10
    v_lshl_add_u32 v6, v10, 6, v9
    v_xor_b32 v7, 64, v6
    v_lshlrev_b32 v8, 4, v1
    s_lshl_b32 s59, s3, 2
    v_mov_b32 v13, s59
    v_mov_b32 v64, 0
    v_mov_b32 v65, 0
    v_mov_b32 v66, 0
    v_mov_b32 v67, 0
    v_mov_b32 v68, 0
    v_mov_b32 v69, 0
    v_mov_b32 v70, 0
    v_mov_b32 v71, 0
    v_mov_b32 v72, 0
    v_mov_b32 v73, 0
    v_mov_b32 v74, 0
    v_mov_b32 v75, 0
    v_mov_b32 v76, 0
    v_mov_b32 v77, 0
    v_mov_b32 v78, 0
    v_mov_b32 v79, 0
    v_mov_b32 v80, 0
    v_mov_b32 v81, 0
    v_mov_b32 v82, 0
    v_mov_b32 v83, 0
    v_mov_b32 v84, 0
    v_mov_b32 v85, 0
    v_mov_b32 v86, 0
    v_mov_b32 v87, 0
    v_mov_b32 v88, 0
    v_mov_b32 v89, 0
    v_mov_b32 v90, 0
    v_mov_b32 v91, 0
    s_mov_b32 exec_lo, 0x00100001
    s_mov_b32 exec_hi, 0x00100001
    v_mov_b32 v88, 0x3f803f80
    v_mov_b32 v89, 0x3f803f80
    v_mov_b32 v90, 0x3f803f80
    v_mov_b32 v91, 0x3f803f80
    s_mov_b64 exec, -1
    s_lshl_b32 s61, s65, 13
    s_cmp_eq_u32 s83, 0
    s_mov_b32 s84, 81920
    s_cselect_b32 s84, 147456, s84
    s_add_u32 s84, s84, s61
    s_branch L_pj2
L_px1:
    s_sub_u32 s65, s3, 4
    s_and_b32 s66, s65, 1
    s_mul_i32 s84, s65, 8320
    s_mul_i32 s78, s83, 16640
    s_mul_i32 s67, s83, 4576
    s_add_u32 s67, s67, 33280
    s_mul_i32 s77, s83, 2568
    s_add_u32 s77, s77, 42432
    v_mov_b32 v16, 0
    v_mov_b32 v17, 0
    v_mov_b32 v18, 0
    v_mov_b32 v19, 0
    v_min_u32 v5, 29, v1
    v_lshl_add_u32 v5, v5, 4, s67
    ds_write_b128 v5, v[16:19]
    v_and_b32 v5, 3, v1
    v_lshlrev_b32 v5, 4, v5
    ds_write_b128 v5, v[16:19] offset:47824
    v_mov_b32 v5, s77
    ds_write_b32 v5, v16
    s_add_u32 s77, s77, 4
    s_lshl_b32 s59, s65, 2
    v_mov_b32 v7, s59
    v_xor_b32 v8, 4, v7
    s_add_u32 s71, s71, 344064
    s_sub_u32 s59, s71, 1605632
    s_cselect_b32 s71, s71, s59
    s_add_u32 s73, s73, 256
    s_sub_u32 s59, s73, 896
    s_cselect_b32 s73, s73, s59
    s_add_u32 s72, s71, 14336
    v_lshrrev_b32 v4, 3, v1
    v_mul_u32_u24 v202, 896, v4
    v_lshrrev_b32 v4, 2, v1
    v_lshrrev_b32 v5, 4, v1
    v_xor_b32 v4, v4, v5
    v_and_b32 v4, 1, v4
    v_lshl_add_u32 v202, v4, 6, v202
    v_and_b32 v4, 3, v1
    v_lshl_add_u32 v202, v4, 4, v202
    s_and_b32 s76, s3, 3
    s_lshl_b32 s60, s57, 7
    s_mul_i32 s74, s76, 401408
    s_add_u32 s74, s74, s60
    s_sub_u32 s74, s74, 7168
    s_lshl_b32 s76, s76, 12
    s_mov_b32 s44, s24
    s_and_b32 s45, s25, 0xffff
    s_mov_b32 s46, 1605632
    s_mov_b32 s47, 0x20000
    s_lshr_b32 s59, s65, 1
    s_lshl_b32 s59, s59, 4
    s_lshr_b32 s59, 0x76d5c4b3, s59
    v_lshrrev_b32 v4, 4, v1
    v_lshlrev_b32 v4, 2, v4
    v_bfe_u32 v4, s59, v4, 4
    s_lshl_b32 s59, s18, 1
    v_add_u32 v4, s59, v4
    v_subrev_u32 v5, 14, v4
    v_min_u32 v4, v4, v5
    v_bfe_u32 v5, v1, 1, 3
    v_lshl_add_u32 v4, v4, 5, v5
    v_mul_u32_u24 v4, 3584, v4
    v_and_b32 v5, 1, v1
    v_lshl_add_u32 v4, v5, 7, v4
    s_and_b32 s59, s53, 3
    s_mul_i32 s59, s59, 28672
    s_lshl_b32 s60, s55, 8
    s_add_u32 s59, s59, s60
    v_add_u32 v86, s59, v4
    s_cmp_eq_u32 s66, 0
    s_cselect_b32 s80, s20, s22
    s_cselect_b32 s81, s21, s23
    s_lshr_b32 s59, s57, 1
    s_lshl_b32 s59, s59, 2
    s_lshr_b32 s59, 0x3362, s59
    s_and_b32 s59, s59, 15
    s_add_u32 s59, s59, s18
    s_sub_u32 s60, s59, 7
    s_cselect_b32 s59, s59, s60
    s_lshl_b32 s59, s59, 7
    s_lshl_b32 s60, s54, 1
    s_and_b32 s61, s57, 1
    s_add_u32 s60, s60, s61
    s_lshl_b32 s60, s60, 2
    s_add_u32 s60, s60, s65
    s_mul_i32 s60, s60, 14336
    s_add_u32 s59, s59, s60
    v_and_b32 v4, 15, v1
    v_mul_u32_u24 v4, 896, v4
    v_add_u32 v87, s59, v4
    s_cmp_eq_u32 s83, 0
    s_mov_b32 s59, 81920
    s_cselect_b32 s59, 147456, s59
    v_lshl_add_u32 v82, v1, 2, s59
    s_xor_b32 s59, s65, 1
    s_mul_i32 s59, s59, 8320
    v_lshl_add_u32 v83, v1, 2, s59
    s_cmp_eq_u32 s66, 1
    s_cbranch_scc1 L_ph3
    v_and_b32 v4, 31, v1
    v_lshrrev_b32 v5, 5, v1
    v_lshl_add_u32 v4, v4, 1, v5
    v_lshl_add_u32 v84, v4, 4, s77
    s_add_u32 s59, s77, 1024
    v_lshl_add_u32 v85, v4, 3, s59
    s_branch L_pj4
L_ph3:
    v_and_b32 v4, 31, v1
    v_lshrrev_b32 v5, 5, v1
    s_add_u32 s59, s77, 1536
    v_lshl_add_u32 v84, v1, 3, s59
    v_lshl_add_u32 v4, v5, 6, v4
    s_add_u32 s59, s77, 2048
    v_lshl_add_u32 v85, v4, 2, s59
L_pj4:
    s_cmp_eq_u32 s66, 1
    s_cbranch_scc1 L_ph5
    v_lshlrev_b32 v4, 4, v1
    v_sub_u32 v4, 2047, v4
    v_mov_b32 v5, 128
    v_cvt_f32_u32 v4, v4
    v_subrev_u32 v5, 0x4300, v5
    v_lshl_add_u32 v5, v5, 2, s77
    v_subrev_f32 v64, 0x0, v4
    v_subrev_f32 v65, 0x3f800000, v4
    v_cvt_pk_bf16_f32 v6, v64, v65
    v_mad_u32_u16 v64, v6, 4, v5
    v_subrev_f32 v72, 0x41000000, v4
    v_subrev_f32 v73, 0x41100000, v4
    v_cvt_pk_bf16_f32 v6, v72, v73
    v_mad_u32_u16 v72, v6, 4, v5
    v_subrev_f32 v80, 0x41800000, v4
    v_subrev_f32 v81, 0x41880000, v4
    v_cvt_pk_bf16_f32 v6, v80, v81
    v_mad_u32_u16 v80, v6, 4, v5
    s_branch L_pj6
L_ph5:
    v_lshlrev_b32 v4, 4, v1
    v_sub_u32 v4, 1023, v4
    v_cmp_gt_u32 vcc, 256, v4
    v_subrev_u32 v5, 16, v4
    v_mov_b32 v6, 144
    v_cndmask_b32 v4, v4, v6, vcc
    v_mov_b32 v6, 128
    v_cndmask_b32 v5, v6, v5, vcc
    v_cvt_f32_u32 v4, v4
    v_subrev_u32 v5, 0x4300, v5
    v_lshl_add_u32 v5, v5, 2, s77
    v_subrev_f32 v64, 0x0, v4
    v_subrev_f32 v65, 0x3f800000, v4
    v_cvt_pk_bf16_f32 v6, v64, v65
    v_mad_u32_u16 v64, v6, 4, v5
    v_mad_u32_u16 v65, v6, 4, v5 op_sel:[1,0,0,0]
    v_subrev_f32 v66, 0x40000000, v4
    v_subrev_f32 v67, 0x40400000, v4
    v_cvt_pk_bf16_f32 v6, v66, v67
    v_mad_u32_u16 v66, v6, 4, v5
    v_mad_u32_u16 v67, v6, 4, v5 op_sel:[1,0,0,0]
    v_subrev_f32 v68, 0x40800000, v4
    v_subrev_f32 v69, 0x40a00000, v4
    v_cvt_pk_bf16_f32 v6, v68, v69
    v_mad_u32_u16 v68, v6, 4, v5
    v_mad_u32_u16 v69, v6, 4, v5 op_sel:[1,0,0,0]
    v_subrev_f32 v70, 0x40c00000, v4
    v_subrev_f32 v71, 0x40e00000, v4
    v_cvt_pk_bf16_f32 v6, v70, v71
    v_mad_u32_u16 v70, v6, 4, v5
    v_mad_u32_u16 v71, v6, 4, v5 op_sel:[1,0,0,0]
    v_subrev_f32 v72, 0x41000000, v4
    v_subrev_f32 v73, 0x41100000, v4
    v_cvt_pk_bf16_f32 v6, v72, v73
    v_mad_u32_u16 v72, v6, 4, v5
    v_mad_u32_u16 v73, v6, 4, v5 op_sel:[1,0,0,0]
    v_subrev_f32 v74, 0x41200000, v4
    v_subrev_f32 v75, 0x41300000, v4
    v_cvt_pk_bf16_f32 v6, v74, v75
    v_mad_u32_u16 v74, v6, 4, v5
    v_mad_u32_u16 v75, v6, 4, v5 op_sel:[1,0,0,0]
    v_subrev_f32 v76, 0x41400000, v4
    v_subrev_f32 v77, 0x41500000, v4
    v_cvt_pk_bf16_f32 v6, v76, v77
    v_mad_u32_u16 v76, v6, 4, v5
    v_mad_u32_u16 v77, v6, 4, v5 op_sel:[1,0,0,0]
    v_subrev_f32 v78, 0x41600000, v4
    v_subrev_f32 v79, 0x41700000, v4
    v_cvt_pk_bf16_f32 v6, v78, v79
    v_mad_u32_u16 v78, v6, 4, v5
    v_mad_u32_u16 v79, v6, 4, v5 op_sel:[1,0,0,0]
    v_subrev_f32 v80, 0x41800000, v4
    v_subrev_f32 v81, 0x41880000, v4
    v_cvt_pk_bf16_f32 v6, v80, v81
    v_mad_u32_u16 v80, v6, 4, v5
L_pj6:
L_pj2:
    s_mov_b32 s48, s30
    s_and_b32 s49, s31, 0xffff
    s_mov_b32 s50, 16777216
    s_mov_b32 s51, 0x20000
    v_lshl_add_u32 v120, v1, 6, s84
    v_bfe_u32 v121, v1, 1, 2
    v_xor_b32 v122, 0, v121
    v_lshl_add_u32 v162, v122, 4, v120
    v_xor_b32 v122, 1, v121
    v_lshl_add_u32 v163, v122, 4, v120
    v_xor_b32 v122, 2, v121
    v_lshl_add_u32 v164, v122, 4, v120
    v_xor_b32 v122, 3, v121
    v_lshl_add_u32 v165, v122, 4, v120
    v_bfe_u32 v121, v1, 2, 2
    v_lshrrev_b32 v120, 5, v1
    v_lshl_add_u32 v120, v120, 3, v121
    v_lshl_add_u32 v120, v120, 6, s84
    v_bfe_u32 v121, v1, 4, 1
    v_lshl_add_u32 v120, v121, 5, v120
    v_lshrrev_b32 v121, 1, v1
    v_lshrrev_b32 v122, 3, v1
    v_xor_b32 v121, v121, v122
    v_and_b32 v121, 1, v121
    v_lshl_add_u32 v120, v121, 4, v120
    v_and_b32 v121, 1, v1
    v_lshl_add_u32 v166, v121, 3, v120
    v_add_u32 v167, 256, v166
    v_xor_b32 v167, 32, v167
    s_waitcnt lgkmcnt(0)
    s_lshl_b32 s59, s63, 16
    s_and_b32 s61, s63, 0xffff0000
    s_cmp_eq_u32 s83, 0
    s_cselect_b32 s59, s59, s61
    v_mov_b32 v120, 0x3fb8aa3b
    v_mul_f32 v120, s59, v120
    v_exp_f32 v120, v120
    s_nop 0
    v_cvt_pk_bf16_f32 v120, v120, v120
    v_lshlrev_b32 v132, 16, v120
    v_add_f32 v133, v132, v132
    v_lshl_add_u32 v120, v1, 2, s84
    s_cmp_ge_u32 s3, 4
    s_cbranch_scc1 L_px7
    s_add_u32 m0, s69, 114688
    s_nop 0
    buffer_load_dwordx4 v200, s[36:39], s71 offen lds
    s_add_u32 m0, s69, 122880
    s_nop 0
    buffer_load_dwordx4 v200, s[40:43], s71 offen lds
    s_add_u32 m0, s69, 115712
    s_add_u32 s71, s71, 114688
    buffer_load_dwordx4 v200, s[36:39], s72 offen lds
    s_add_u32 m0, s69, 123904
    s_cmp_eq_u32 s71, 1605632
    buffer_load_dwordx4 v200, s[40:43], s72 offen lds
    s_cselect_b32 s71, 0, s71
    s_add_u32 s72, s71, 14336
    s_waitcnt vmcnt(12)
    s_branch L_pj8
L_px7:
    s_waitcnt vmcnt(0)
L_pj8:
    v_lshlrev_b32 v128, 16, v128
    v_lshlrev_b32 v129, 16, v129
    v_lshlrev_b32 v130, 16, v130
    v_lshlrev_b32 v131, 16, v131
    v_mul_f32 v142, 0x3fb8aa3b, v128
    v_exp_f32 v142, v142
    v_mul_f32 v135, v129, v132
    s_setprio 1
    v_cvt_pk_bf16_f32 v142, v142, v142
    v_mul_f32 v135, 0x3e22f983, v135
    v_lshlrev_b32 v142, 16, v142
    v_mul_f32 v142, v142, v132
    v_mul_f32 v134, 0xbfb8aa3b, v142
    v_fract_f32 v149, v135
    v_exp_f32 v148, v134
    v_cos_f32 v136, v149
    v_sin_f32 v137, v149
    v_mul_f32 v150, 0x41000000, v134
    v_mul_f32 v151, 0x41000000, v135
    v_fract_f32 v151, v151
    v_exp_f32 v150, v150
    v_cos_f32 v138, v151
    v_sin_f32 v139, v151
    v_mul_f32 v152, 0x43800000, v134
    v_mul_f32 v153, 0x43800000, v135
    v_fract_f32 v153, v153
    v_exp_f32 v152, v152
    v_cos_f32 v140, v153
    v_sin_f32 v141, v153
    s_nop 0
    v_pk_mul_f32 v[146:147], v[130:131], v[132:133] op_sel:[0,1] op_sel_hi:[1,1]
    v_pk_mul_f32 v[136:137], v[136:137], v[148:149] op_sel_hi:[1,0]
    v_pk_mul_f32 v[138:139], v[138:139], v[150:151] op_sel_hi:[1,0] neg_hi:[1,0]
    v_pk_mul_f32 v[140:141], v[140:141], v[152:153] op_sel_hi:[1,0]
    v_pk_mul_f32 v[142:143], v[146:147], v[136:137] op_sel:[1,1] op_sel_hi:[1,0]
    v_pk_mul_f32 v[144:145], v[136:137], v[136:137] op_sel:[1,1] op_sel_hi:[1,0]
    v_pk_fma_f32 v[148:149], v[146:147], v[136:137], v[142:143] op_sel:[0,0,0] op_sel_hi:[0,1,1] neg_lo:[0,0,1]
    v_pk_fma_f32 v[134:135], v[136:137], v[136:137], v[144:145] op_sel:[0,0,0] op_sel_hi:[0,1,1] neg_lo:[0,0,1]
    v_cvt_pk_bf16_f32 v48, v146, v148
    v_cvt_pk_bf16_f32 v52, v147, v149
    v_pk_mul_f32 v[142:143], v[146:147], v[134:135] op_sel:[1,1] op_sel_hi:[1,0]
    v_pk_mul_f32 v[144:145], v[148:149], v[134:135] op_sel:[1,1] op_sel_hi:[1,0]
    v_pk_fma_f32 v[150:151], v[146:147], v[134:135], v[142:143] op_sel:[0,0,0] op_sel_hi:[0,1,1] neg_lo:[0,0,1]
    v_pk_fma_f32 v[152:153], v[148:149], v[134:135], v[144:145] op_sel:[0,0,0] op_sel_hi:[0,1,1] neg_lo:[0,0,1]
    v_cvt_pk_bf16_f32 v49, v150, v152
    v_cvt_pk_bf16_f32 v53, v151, v153
    v_pk_mul_f32 v[142:143], v[150:151], v[134:135] op_sel:[1,1] op_sel_hi:[1,0]
    v_pk_mul_f32 v[144:145], v[152:153], v[134:135] op_sel:[1,1] op_sel_hi:[1,0]
    v_pk_fma_f32 v[154:155], v[150:151], v[134:135], v[142:143] op_sel:[0,0,0] op_sel_hi:[0,1,1] neg_lo:[0,0,1]
    v_pk_fma_f32 v[156:157], v[152:153], v[134:135], v[144:145] op_sel:[0,0,0] op_sel_hi:[0,1,1] neg_lo:[0,0,1]
    v_cvt_pk_bf16_f32 v50, v154, v156
    v_cvt_pk_bf16_f32 v54, v155, v157
    v_pk_mul_f32 v[142:143], v[154:155], v[134:135] op_sel:[1,1] op_sel_hi:[1,0]
    v_pk_mul_f32 v[144:145], v[156:157], v[134:135] op_sel:[1,1] op_sel_hi:[1,0]
    v_pk_fma_f32 v[158:159], v[154:155], v[134:135], v[142:143] op_sel:[0,0,0] op_sel_hi:[0,1,1] neg_lo:[0,0,1]
    v_pk_fma_f32 v[160:161], v[156:157], v[134:135], v[144:145] op_sel:[0,0,0] op_sel_hi:[0,1,1] neg_lo:[0,0,1]
    v_cvt_pk_bf16_f32 v51, v158, v160
    v_cvt_pk_bf16_f32 v55, v159, v161
    ds_write_b128 v162, v[48:51]
    ds_write_b128 v162, v[52:55] offset:4096
    s_setprio 0
    v_pk_mul_f32 v[142:143], v[146:147], v[140:141] op_sel:[1,1] op_sel_hi:[1,0]
    v_pk_mul_f32 v[144:145], v[150:151], v[140:141] op_sel:[1,1] op_sel_hi:[1,0]
    v_pk_fma_f32 v[146:147], v[146:147], v[140:141], v[142:143] op_sel:[0,0,0] op_sel_hi:[0,1,1] neg_lo:[0,0,1]
    s_setprio 1
    v_pk_fma_f32 v[150:151], v[150:151], v[140:141], v[144:145] op_sel:[0,0,0] op_sel_hi:[0,1,1] neg_lo:[0,0,1]
    v_cvt_pk_bf16_f32 v56, v146, v150
    v_cvt_pk_bf16_f32 v60, v147, v151
    v_pk_mul_f32 v[142:143], v[154:155], v[140:141] op_sel:[1,1] op_sel_hi:[1,0]
    v_pk_mul_f32 v[144:145], v[158:159], v[140:141] op_sel:[1,1] op_sel_hi:[1,0]
    v_pk_fma_f32 v[154:155], v[154:155], v[140:141], v[142:143] op_sel:[0,0,0] op_sel_hi:[0,1,1] neg_lo:[0,0,1]
    v_pk_fma_f32 v[158:159], v[158:159], v[140:141], v[144:145] op_sel:[0,0,0] op_sel_hi:[0,1,1] neg_lo:[0,0,1]
    v_cvt_pk_bf16_f32 v58, v154, v158
    v_cvt_pk_bf16_f32 v62, v155, v159
    v_pk_mul_f32 v[142:143], v[146:147], v[140:141] op_sel:[1,1] op_sel_hi:[1,0]
    v_pk_mul_f32 v[144:145], v[154:155], v[140:141] op_sel:[1,1] op_sel_hi:[1,0]
    v_pk_fma_f32 v[148:149], v[146:147], v[140:141], v[142:143] op_sel:[0,0,0] op_sel_hi:[0,1,1] neg_lo:[0,0,1]
    v_pk_fma_f32 v[154:155], v[154:155], v[140:141], v[144:145] op_sel:[0,0,0] op_sel_hi:[0,1,1] neg_lo:[0,0,1]
    v_cvt_pk_bf16_f32 v57, v148, v154
    v_cvt_pk_bf16_f32 v61, v149, v155
    v_pk_mul_f32 v[142:143], v[148:149], v[140:141] op_sel:[1,1] op_sel_hi:[1,0]
    v_pk_mul_f32 v[144:145], v[154:155], v[140:141] op_sel:[1,1] op_sel_hi:[1,0]
    v_pk_fma_f32 v[146:147], v[148:149], v[140:141], v[142:143] op_sel:[0,0,0] op_sel_hi:[0,1,1] neg_lo:[0,0,1]
    v_pk_fma_f32 v[154:155], v[154:155], v[140:141], v[144:145] op_sel:[0,0,0] op_sel_hi:[0,1,1] neg_lo:[0,0,1]
    v_cvt_pk_bf16_f32 v59, v146, v154
    v_cvt_pk_bf16_f32 v63, v147, v155
    ds_write_b128 v163, v[56:59]
    ds_write_b128 v163, v[60:63] offset:4096
    s_setprio 0
    v_pk_mul_f32 v[142:143], v[140:141], v[140:141] op_sel:[1,1] op_sel_hi:[1,0]
    v_pk_mul_f32 v[144:145], v[138:139], v[138:139] op_sel:[1,1] op_sel_hi:[1,0]
    v_pk_fma_f32 v[150:151], v[140:141], v[140:141], v[142:143] op_sel:[0,0,0] op_sel_hi:[0,1,1] neg_lo:[0,0,1]
    s_setprio 1
    v_pk_fma_f32 v[136:137], v[138:139], v[138:139], v[144:145] op_sel:[0,0,0] op_sel_hi:[0,1,1] neg_lo:[0,0,1]
    v_pk_mul_f32 v[142:143], v[148:149], v[150:151] op_sel:[1,1] op_sel_hi:[1,0]
    v_pk_mul_f32 v[144:145], v[146:147], v[150:151] op_sel:[1,1] op_sel_hi:[1,0]
    v_pk_fma_f32 v[148:149], v[148:149], v[150:151], v[142:143] op_sel:[0,0,0] op_sel_hi:[0,1,1] neg_lo:[0,0,1]
    v_pk_fma_f32 v[146:147], v[146:147], v[150:151], v[144:145] op_sel:[0,0,0] op_sel_hi:[0,1,1] neg_lo:[0,0,1]
    v_cvt_pk_bf16_f32 v48, v148, v146
    v_cvt_pk_bf16_f32 v52, v149, v147
    v_pk_mul_f32 v[142:143], v[148:149], v[150:151] op_sel:[1,1] op_sel_hi:[1,0]
    v_pk_mul_f32 v[144:145], v[146:147], v[150:151] op_sel:[1,1] op_sel_hi:[1,0]
    v_pk_fma_f32 v[148:149], v[148:149], v[150:151], v[142:143] op_sel:[0,0,0] op_sel_hi:[0,1,1] neg_lo:[0,0,1]
    v_pk_fma_f32 v[146:147], v[146:147], v[150:151], v[144:145] op_sel:[0,0,0] op_sel_hi:[0,1,1] neg_lo:[0,0,1]
    v_cvt_pk_bf16_f32 v50, v148, v146
    v_cvt_pk_bf16_f32 v54, v149, v147
    v_pk_mul_f32 v[142:143], v[148:149], v[150:151] op_sel:[1,1] op_sel_hi:[1,0]
    v_pk_mul_f32 v[144:145], v[138:139], v[136:137] op_sel:[1,1] op_sel_hi:[1,0]
    v_pk_fma_f32 v[148:149], v[148:149], v[150:151], v[142:143] op_sel:[0,0,0] op_sel_hi:[0,1,1] neg_lo:[0,0,1]
    v_pk_fma_f32 v[156:157], v[138:139], v[136:137], v[144:145] op_sel:[0,0,0] op_sel_hi:[0,1,1] neg_lo:[0,0,1]
    v_cvt_pk_bf16_f32 v49, v148, v148
    v_cvt_pk_bf16_f32 v53, v149, v149
    ds_write_b128 v164, v[48:51]
    ds_write_b128 v164, v[52:55] offset:4096
    s_setprio 0
    s_nop 0
    ds_read_b64_tr_b16 v[16:17], v166 offset:0
    ds_read_b64_tr_b16 v[18:19], v167 offset:0
    ds_read_b64_tr_b16 v[20:21], v166 offset:1024
    ds_read_b64_tr_b16 v[22:23], v167 offset:1024
    ds_read_b64_tr_b16 v[24:25], v166 offset:2048
    ds_read_b64_tr_b16 v[26:27], v167 offset:2048
    ds_read_b64_tr_b16 v[28:29], v166 offset:3072
    ds_read_b64_tr_b16 v[30:31], v167 offset:3072
    ds_read_b64_tr_b16 v[32:33], v166 offset:4096
    ds_read_b64_tr_b16 v[34:35], v167 offset:4096
    ds_read_b64_tr_b16 v[36:37], v166 offset:5120
    ds_read_b64_tr_b16 v[38:39], v167 offset:5120
    ds_read_b64_tr_b16 v[40:41], v166 offset:6144
    ds_read_b64_tr_b16 v[42:43], v167 offset:6144
    ds_read_b64_tr_b16 v[44:45], v166 offset:7168
    ds_read_b64_tr_b16 v[46:47], v167 offset:7168
    s_cmp_ge_u32 s3, 4
    s_cbranch_scc1 L_hx9
    s_add_u32 m0, s69, 131072
    s_nop 0
    buffer_load_dwordx4 v200, s[36:39], s71 offen lds
    s_add_u32 m0, s69, 139264
    s_nop 0
    buffer_load_dwordx4 v200, s[40:43], s71 offen lds
    s_add_u32 m0, s69, 132096
    s_add_u32 s71, s71, 114688
    buffer_load_dwordx4 v200, s[36:39], s72 offen lds
    s_add_u32 m0, s69, 140288
    s_cmp_eq_u32 s71, 1605632
    buffer_load_dwordx4 v200, s[40:43], s72 offen lds
    s_cselect_b32 s71, 0, s71
    s_add_u32 s72, s71, 14336
    s_branch L_hj10
L_hx9:
    global_load_dword v88, v87, s[4:5]
    global_load_dword v89, v86, s[80:81]
L_hj10:
    v_cvt_pk_bf16_f32 v56, 1.0, v138
    v_cvt_pk_bf16_f32 v60, 0, v139
    v_cvt_pk_bf16_f32 v57, v136, v156
    s_setprio 1
    s_nop 0
    v_cvt_pk_bf16_f32 v61, v137, v157
    v_pk_mul_f32 v[142:143], v[136:137], v[136:137] op_sel:[1,1] op_sel_hi:[1,0]
    v_pk_mul_f32 v[144:145], v[156:157], v[136:137] op_sel:[1,1] op_sel_hi:[1,0]
    v_pk_fma_f32 v[152:153], v[136:137], v[136:137], v[142:143] op_sel:[0,0,0] op_sel_hi:[0,1,1] neg_lo:[0,0,1]
    v_pk_fma_f32 v[156:157], v[156:157], v[136:137], v[144:145] op_sel:[0,0,0] op_sel_hi:[0,1,1] neg_lo:[0,0,1]
    v_cvt_pk_bf16_f32 v58, v152, v156
    v_cvt_pk_bf16_f32 v62, v153, v157
    v_pk_mul_f32 v[142:143], v[152:153], v[136:137] op_sel:[1,1] op_sel_hi:[1,0]
    v_pk_mul_f32 v[144:145], v[156:157], v[136:137] op_sel:[1,1] op_sel_hi:[1,0]
    v_pk_fma_f32 v[152:153], v[152:153], v[136:137], v[142:143] op_sel:[0,0,0] op_sel_hi:[0,1,1] neg_lo:[0,0,1]
    v_pk_fma_f32 v[156:157], v[156:157], v[136:137], v[144:145] op_sel:[0,0,0] op_sel_hi:[0,1,1] neg_lo:[0,0,1]
    v_cvt_pk_bf16_f32 v59, v152, v156
    v_cvt_pk_bf16_f32 v63, v153, v157
    ds_write_b128 v162, v[56:59]
    ds_write_b128 v162, v[60:63] offset:4096
    s_setprio 0
    v_pk_mul_f32 v[142:143], v[152:153], v[136:137] op_sel:[1,1] op_sel_hi:[1,0]
    v_pk_mul_f32 v[144:145], v[156:157], v[136:137] op_sel:[1,1] op_sel_hi:[1,0]
    v_pk_fma_f32 v[152:153], v[152:153], v[136:137], v[142:143] op_sel:[0,0,0] op_sel_hi:[0,1,1] neg_lo:[0,0,1]
    s_setprio 1
    v_pk_fma_f32 v[156:157], v[156:157], v[136:137], v[144:145] op_sel:[0,0,0] op_sel_hi:[0,1,1] neg_lo:[0,0,1]
    v_cvt_pk_bf16_f32 v48, v152, v156
    v_cvt_pk_bf16_f32 v52, v153, v157
    v_pk_mul_f32 v[142:143], v[152:153], v[136:137] op_sel:[1,1] op_sel_hi:[1,0]
    v_pk_mul_f32 v[144:145], v[156:157], v[136:137] op_sel:[1,1] op_sel_hi:[1,0]
    v_pk_fma_f32 v[152:153], v[152:153], v[136:137], v[142:143] op_sel:[0,0,0] op_sel_hi:[0,1,1] neg_lo:[0,0,1]
    v_pk_fma_f32 v[156:157], v[156:157], v[136:137], v[144:145] op_sel:[0,0,0] op_sel_hi:[0,1,1] neg_lo:[0,0,1]
    v_cvt_pk_bf16_f32 v49, v152, v156
    v_cvt_pk_bf16_f32 v53, v153, v157
    v_pk_mul_f32 v[142:143], v[152:153], v[136:137] op_sel:[1,1] op_sel_hi:[1,0]
    v_pk_mul_f32 v[144:145], v[156:157], v[136:137] op_sel:[1,1] op_sel_hi:[1,0]
    v_pk_fma_f32 v[152:153], v[152:153], v[136:137], v[142:143] op_sel:[0,0,0] op_sel_hi:[0,1,1] neg_lo:[0,0,1]
    v_pk_fma_f32 v[156:157], v[156:157], v[136:137], v[144:145] op_sel:[0,0,0] op_sel_hi:[0,1,1] neg_lo:[0,0,1]
    v_cvt_pk_bf16_f32 v50, v152, v156
    v_cvt_pk_bf16_f32 v54, v153, v157
    v_pk_mul_f32 v[142:143], v[152:153], v[136:137] op_sel:[1,1] op_sel_hi:[1,0]
    v_pk_mul_f32 v[144:145], v[156:157], v[136:137] op_sel:[1,1] op_sel_hi:[1,0]
    v_pk_fma_f32 v[152:153], v[152:153], v[136:137], v[142:143] op_sel:[0,0,0] op_sel_hi:[0,1,1] neg_lo:[0,0,1]
    v_pk_fma_f32 v[156:157], v[156:157], v[136:137], v[144:145] op_sel:[0,0,0] op_sel_hi:[0,1,1] neg_lo:[0,0,1]
    v_cvt_pk_bf16_f32 v51, v152, v156
    v_cvt_pk_bf16_f32 v55, v153, v157
    ds_write_b128 v163, v[48:51]
    ds_write_b128 v163, v[52:55] offset:4096
    s_setprio 0
    v_pk_mul_f32 v[142:143], v[152:153], v[136:137] op_sel:[1,1] op_sel_hi:[1,0]
    v_pk_mul_f32 v[144:145], v[156:157], v[136:137] op_sel:[1,1] op_sel_hi:[1,0]
    v_pk_fma_f32 v[152:153], v[152:153], v[136:137], v[142:143] op_sel:[0,0,0] op_sel_hi:[0,1,1] neg_lo:[0,0,1]
    s_setprio 1
    v_pk_fma_f32 v[156:157], v[156:157], v[136:137], v[144:145] op_sel:[0,0,0] op_sel_hi:[0,1,1] neg_lo:[0,0,1]
    v_cvt_pk_bf16_f32 v56, v152, v156
    v_cvt_pk_bf16_f32 v60, v153, v157
    v_pk_mul_f32 v[142:143], v[152:153], v[136:137] op_sel:[1,1] op_sel_hi:[1,0]
    v_pk_mul_f32 v[144:145], v[156:157], v[136:137] op_sel:[1,1] op_sel_hi:[1,0]
    v_pk_fma_f32 v[152:153], v[152:153], v[136:137], v[142:143] op_sel:[0,0,0] op_sel_hi:[0,1,1] neg_lo:[0,0,1]
    v_pk_fma_f32 v[156:157], v[156:157], v[136:137], v[144:145] op_sel:[0,0,0] op_sel_hi:[0,1,1] neg_lo:[0,0,1]
    v_cvt_pk_bf16_f32 v57, v152, v156
    v_cvt_pk_bf16_f32 v61, v153, v157
    v_pk_mul_f32 v[142:143], v[152:153], v[136:137] op_sel:[1,1] op_sel_hi:[1,0]
    v_pk_mul_f32 v[144:145], v[156:157], v[136:137] op_sel:[1,1] op_sel_hi:[1,0]
    v_pk_fma_f32 v[152:153], v[152:153], v[136:137], v[142:143] op_sel:[0,0,0] op_sel_hi:[0,1,1] neg_lo:[0,0,1]
    v_pk_fma_f32 v[156:157], v[156:157], v[136:137], v[144:145] op_sel:[0,0,0] op_sel_hi:[0,1,1] neg_lo:[0,0,1]
    v_cvt_pk_bf16_f32 v58, v152, v156
    v_cvt_pk_bf16_f32 v62, v153, v157
    v_pk_mul_f32 v[142:143], v[152:153], v[136:137] op_sel:[1,1] op_sel_hi:[1,0]
    v_pk_mul_f32 v[144:145], v[156:157], v[136:137] op_sel:[1,1] op_sel_hi:[1,0]
    v_pk_fma_f32 v[152:153], v[152:153], v[136:137], v[142:143] op_sel:[0,0,0] op_sel_hi:[0,1,1] neg_lo:[0,0,1]
    v_pk_fma_f32 v[156:157], v[156:157], v[136:137], v[144:145] op_sel:[0,0,0] op_sel_hi:[0,1,1] neg_lo:[0,0,1]
    v_cvt_pk_bf16_f32 v59, v152, v156
    v_cvt_pk_bf16_f32 v63, v153, v157
    ds_write_b128 v164, v[56:59]
    ds_write_b128 v164, v[60:63] offset:4096
    s_setprio 0
    v_pk_mul_f32 v[142:143], v[152:153], v[136:137] op_sel:[1,1] op_sel_hi:[1,0]
    v_pk_mul_f32 v[144:145], v[156:157], v[136:137] op_sel:[1,1] op_sel_hi:[1,0]
    v_pk_fma_f32 v[152:153], v[152:153], v[136:137], v[142:143] op_sel:[0,0,0] op_sel_hi:[0,1,1] neg_lo:[0,0,1]
    s_setprio 1
    v_pk_fma_f32 v[156:157], v[156:157], v[136:137], v[144:145] op_sel:[0,0,0] op_sel_hi:[0,1,1] neg_lo:[0,0,1]
    v_cvt_pk_bf16_f32 v48, v152, v156
    v_cvt_pk_bf16_f32 v52, v153, v157
    v_pk_mul_f32 v[142:143], v[152:153], v[136:137] op_sel:[1,1] op_sel_hi:[1,0]
    v_pk_mul_f32 v[144:145], v[156:157], v[136:137] op_sel:[1,1] op_sel_hi:[1,0]
    v_pk_fma_f32 v[152:153], v[152:153], v[136:137], v[142:143] op_sel:[0,0,0] op_sel_hi:[0,1,1] neg_lo:[0,0,1]
    v_pk_fma_f32 v[156:157], v[156:157], v[136:137], v[144:145] op_sel:[0,0,0] op_sel_hi:[0,1,1] neg_lo:[0,0,1]
    v_cvt_pk_bf16_f32 v49, v152, v156
    v_cvt_pk_bf16_f32 v53, v153, v157
    v_pk_mul_f32 v[142:143], v[152:153], v[136:137] op_sel:[1,1] op_sel_hi:[1,0]
    v_pk_mul_f32 v[144:145], v[156:157], v[136:137] op_sel:[1,1] op_sel_hi:[1,0]
    v_pk_fma_f32 v[152:153], v[152:153], v[136:137], v[142:143] op_sel:[0,0,0] op_sel_hi:[0,1,1] neg_lo:[0,0,1]
    v_pk_fma_f32 v[156:157], v[156:157], v[136:137], v[144:145] op_sel:[0,0,0] op_sel_hi:[0,1,1] neg_lo:[0,0,1]
    v_cvt_pk_bf16_f32 v50, v152, v156
    v_cvt_pk_bf16_f32 v54, v153, v157
    v_pk_mul_f32 v[142:143], v[152:153], v[136:137] op_sel:[1,1] op_sel_hi:[1,0]
    v_pk_mul_f32 v[144:145], v[156:157], v[136:137] op_sel:[1,1] op_sel_hi:[1,0]
    v_pk_fma_f32 v[152:153], v[152:153], v[136:137], v[142:143] op_sel:[0,0,0] op_sel_hi:[0,1,1] neg_lo:[0,0,1]
    v_pk_fma_f32 v[156:157], v[156:157], v[136:137], v[144:145] op_sel:[0,0,0] op_sel_hi:[0,1,1] neg_lo:[0,0,1]
    v_cvt_pk_bf16_f32 v51, v152, v156
    v_cvt_pk_bf16_f32 v55, v153, v157
    ds_write_b128 v165, v[48:51]
    ds_write_b128 v165, v[52:55] offset:4096
    s_setprio 0
    s_nop 0
    ds_read_b64_tr_b16 v[168:169], v166 offset:0
    ds_read_b64_tr_b16 v[170:171], v167 offset:0
    ds_read_b64_tr_b16 v[172:173], v166 offset:1024
    ds_read_b64_tr_b16 v[174:175], v167 offset:1024
    ds_read_b64_tr_b16 v[176:177], v166 offset:2048
    ds_read_b64_tr_b16 v[178:179], v167 offset:2048
    ds_read_b64_tr_b16 v[180:181], v166 offset:3072
    ds_read_b64_tr_b16 v[182:183], v167 offset:3072
    ds_read_b64_tr_b16 v[184:185], v166 offset:4096
    ds_read_b64_tr_b16 v[186:187], v167 offset:4096
    ds_read_b64_tr_b16 v[188:189], v166 offset:5120
    ds_read_b64_tr_b16 v[190:191], v167 offset:5120
    ds_read_b64_tr_b16 v[192:193], v166 offset:6144
    ds_read_b64_tr_b16 v[194:195], v167 offset:6144
    ds_read_b64_tr_b16 v[196:197], v166 offset:7168
    ds_read_b64_tr_b16 v[198:199], v167 offset:7168
    s_cmp_ge_u32 s3, 4
    s_cbranch_scc1 L_hx11
    s_branch L_hj12
L_hx11:
L_hj12:
    s_waitcnt lgkmcnt(14)
    v_mfma_f32_32x32x16_bf16 v[104:119], v[16:19], v[168:171], 0
    s_waitcnt lgkmcnt(12)
    v_mfma_f32_32x32x16_bf16 v[104:119], v[20:23], v[172:175], v[104:119]
    s_waitcnt lgkmcnt(10)
    v_mfma_f32_32x32x16_bf16 v[104:119], v[24:27], v[176:179], v[104:119]
    s_waitcnt lgkmcnt(8)
    v_mfma_f32_32x32x16_bf16 v[104:119], v[28:31], v[180:183], v[104:119]
    s_waitcnt lgkmcnt(6)
    v_mfma_f32_32x32x16_bf16 v[104:119], v[32:35], v[184:187], v[104:119]
    s_waitcnt lgkmcnt(4)
    v_mfma_f32_32x32x16_bf16 v[104:119], v[36:39], v[188:191], v[104:119]
    s_waitcnt lgkmcnt(2)
    v_mfma_f32_32x32x16_bf16 v[104:119], v[40:43], v[192:195], v[104:119]
    s_waitcnt lgkmcnt(0)
    v_mfma_f32_32x32x16_bf16 v[104:119], v[44:47], v[196:199], v[104:119]
    s_nop 11
    ds_write2st64_b32 v120, v104, v105 offset0:0 offset1:1
    ds_write2st64_b32 v120, v106, v107 offset0:2 offset1:3
    ds_write2st64_b32 v120, v108, v109 offset0:4 offset1:5
    ds_write2st64_b32 v120, v110, v111 offset0:6 offset1:7
    ds_write2st64_b32 v120, v112, v113 offset0:8 offset1:9
    ds_write_b32 v120, v114 offset:2560
    s_cmp_ge_u32 s3, 4
    s_cbranch_scc1 L_xw
    s_lshl_b32 s59, s54, 1
    s_add_u32 s59, s59, s65
    s_lshl_b32 s60, s55, 1
    s_add_u32 s60, s60, s66
    s_mul_i32 s61, s59, 229376
    s_lshl_b32 s62, s60, 12
    s_add_u32 s61, s61, s62
    s_add_u32 s61, s61, 4194304
    s_lshl_b32 s62, s65, 11
    s_add_u32 s78, s61, s62
    s_xor_b32 s79, s78, 2048
    s_add_u32 s80, s78, 114688
    s_add_u32 s81, s79, 114688
    s_lshl_b32 s63, s59, 10
    s_add_u32 s63, s63, 2228224
    s_mul_i32 s60, s60, 37
    s_lshr_b32 s60, s60, 8
    s_lshl_b32 s60, s60, 7
    s_add_u32 s63, s63, s60
    s_add_u32 s16, s30, s63
    s_addc_u32 s17, s31, 0
    s_lshl_b32 s77, s56, 3
    s_add_u32 s77, s77, s3
    s_lshl_b32 s77, s77, 7
    s_add_u32 s77, s77, 2228224
    s_waitcnt vmcnt(8)
    s_waitcnt lgkmcnt(0)
    s_barrier
    s_nop 0
    ds_read_b128 v[16:19], v2 offset:0
    ds_read_b64_tr_b16 v[24:25], v6 offset:0
    ds_read_b64_tr_b16 v[26:27], v6 offset:1024
    ds_read_b64_tr_b16 v[32:33], v6 offset:8192
    ds_read_b64_tr_b16 v[34:35], v6 offset:9216
    ds_read_b128 v[20:23], v2 offset:4096
    ds_read_b64_tr_b16 v[28:29], v7 offset:0
    ds_read_b64_tr_b16 v[30:31], v7 offset:1024
    ds_read_b64_tr_b16 v[36:37], v7 offset:8192
    ds_read_b64_tr_b16 v[38:39], v7 offset:9216
    s_add_u32 m0, s70, 65536
    s_add_u32 s59, s73, 0
    s_nop 0
    buffer_load_dwordx4 v201, s[32:35], s59 offen lds
    s_add_u32 m0, s70, 69632
    s_add_u32 s59, s73, 28672
    buffer_load_dwordx4 v201, s[32:35], s59 offen lds
    s_add_u32 m0, s70, 73728
    s_add_u32 s59, s73, 57344
    buffer_load_dwordx4 v201, s[32:35], s59 offen lds
    s_add_u32 m0, s70, 77824
    s_add_u32 s59, s73, 86016
    buffer_load_dwordx4 v201, s[32:35], s59 offen lds
    s_add_u32 s73, s73, 128
    s_cmp_eq_u32 s73, 896
    s_cselect_b32 s73, 0, s73
    s_waitcnt lgkmcnt(0)
    v_mfma_f32_32x32x16_bf16 v[128:143], v[24:27], v[16:19], 0
    ds_read_b128 v[40:43], v3 offset:0
    ds_read_b64_tr_b16 v[48:49], v6 offset:4096
    v_mfma_f32_32x32x16_bf16 v[192:207], v[32:35], v[16:19], 0
    ds_read_b64_tr_b16 v[50:51], v6 offset:5120
    ds_read_b64_tr_b16 v[56:57], v6 offset:12288
    v_mfma_f32_32x32x16_bf16 v[144:159], v[24:27], v[20:23], 0
    ds_read_b64_tr_b16 v[58:59], v6 offset:13312
    ds_read_b128 v[44:47], v3 offset:4096
    v_mfma_f32_32x32x16_bf16 v[208:223], v[32:35], v[20:23], 0
    ds_read_b64_tr_b16 v[52:53], v7 offset:4096
    ds_read_b64_tr_b16 v[54:55], v7 offset:5120
    v_mfma_f32_32x32x16_bf16 v[160:175], v[28:31], v[16:19], 0
    ds_read_b64_tr_b16 v[60:61], v7 offset:12288
    ds_read_b64_tr_b16 v[62:63], v7 offset:13312
    v_mfma_f32_16x16x32_bf16 v[96:99], v[88:91], v[24:27], 0
    v_mfma_f32_16x16x32_bf16 v[100:103], v[88:91], v[32:35], 0
    v_mfma_f32_32x32x16_bf16 v[224:239], v[36:39], v[16:19], 0
    v_mfma_f32_32x32x16_bf16 v[176:191], v[28:31], v[20:23], 0
    s_waitcnt lgkmcnt(0)
    v_mfma_f32_32x32x16_bf16 v[240:255], v[36:39], v[20:23], 0
    s_waitcnt vmcnt(8)
    s_barrier
    s_nop 0
    v_mfma_f32_32x32x16_bf16 v[128:143], v[48:51], v[40:43], v[128:143]
    ds_read_b128 v[16:19], v4 offset:0
    ds_read_b64_tr_b16 v[24:25], v6 offset:16384
    v_mfma_f32_32x32x16_bf16 v[192:207], v[56:59], v[40:43], v[192:207]
    ds_read_b64_tr_b16 v[26:27], v6 offset:17408
    ds_read_b64_tr_b16 v[32:33], v6 offset:24576
    v_mfma_f32_32x32x16_bf16 v[144:159], v[48:51], v[44:47], v[144:159]
    ds_read_b64_tr_b16 v[34:35], v6 offset:25600
    ds_read_b128 v[20:23], v4 offset:4096
    v_mfma_f32_32x32x16_bf16 v[208:223], v[56:59], v[44:47], v[208:223]
    ds_read_b64_tr_b16 v[28:29], v7 offset:16384
    ds_read_b64_tr_b16 v[30:31], v7 offset:17408
    v_mfma_f32_32x32x16_bf16 v[160:175], v[52:55], v[40:43], v[160:175]
    ds_read_b64_tr_b16 v[36:37], v7 offset:24576
    ds_read_b64_tr_b16 v[38:39], v7 offset:25600
    v_mfma_f32_16x16x32_bf16 v[96:99], v[88:91], v[48:51], v[96:99]
    v_mfma_f32_16x16x32_bf16 v[100:103], v[88:91], v[56:59], v[100:103]
    v_mfma_f32_32x32x16_bf16 v[224:239], v[60:63], v[40:43], v[224:239]
    v_mfma_f32_32x32x16_bf16 v[176:191], v[52:55], v[44:47], v[176:191]
    s_waitcnt lgkmcnt(0)
    s_nop 0
    v_mfma_f32_32x32x16_bf16 v[240:255], v[60:63], v[44:47], v[240:255]
    v_mfma_f32_32x32x16_bf16 v[128:143], v[24:27], v[16:19], v[128:143]
    ds_read_b128 v[40:43], v5 offset:0
    ds_read_b64_tr_b16 v[48:49], v6 offset:20480
    v_mfma_f32_32x32x16_bf16 v[192:207], v[32:35], v[16:19], v[192:207]
    ds_read_b64_tr_b16 v[50:51], v6 offset:21504
    ds_read_b64_tr_b16 v[56:57], v6 offset:28672
    v_mfma_f32_32x32x16_bf16 v[144:159], v[24:27], v[20:23], v[144:159]
    ds_read_b64_tr_b16 v[58:59], v6 offset:29696
    ds_read_b128 v[44:47], v5 offset:4096
    v_mfma_f32_32x32x16_bf16 v[208:223], v[32:35], v[20:23], v[208:223]
    ds_read_b64_tr_b16 v[52:53], v7 offset:20480
    ds_read_b64_tr_b16 v[54:55], v7 offset:21504
    v_mfma_f32_32x32x16_bf16 v[160:175], v[28:31], v[16:19], v[160:175]
    ds_read_b64_tr_b16 v[60:61], v7 offset:28672
    ds_read_b64_tr_b16 v[62:63], v7 offset:29696
    v_mfma_f32_16x16x32_bf16 v[96:99], v[88:91], v[24:27], v[96:99]
    v_mfma_f32_16x16x32_bf16 v[100:103], v[88:91], v[32:35], v[100:103]
    v_mfma_f32_32x32x16_bf16 v[224:239], v[36:39], v[16:19], v[224:239]
    v_mfma_f32_32x32x16_bf16 v[176:191], v[28:31], v[20:23], v[176:191]
    s_waitcnt lgkmcnt(0)
    v_mfma_f32_32x32x16_bf16 v[240:255], v[36:39], v[20:23], v[240:255]
    s_waitcnt vmcnt(0)
    s_barrier
    s_nop 0
    v_mfma_f32_32x32x16_bf16 v[128:143], v[48:51], v[40:43], v[128:143]
    ds_read_b128 v[16:19], v2 offset:16384
    ds_read_b64_tr_b16 v[24:25], v6 offset:32768
    v_mfma_f32_32x32x16_bf16 v[192:207], v[56:59], v[40:43], v[192:207]
    ds_read_b64_tr_b16 v[26:27], v6 offset:33792
    ds_read_b64_tr_b16 v[32:33], v6 offset:40960
    v_mfma_f32_32x32x16_bf16 v[144:159], v[48:51], v[44:47], v[144:159]
    ds_read_b64_tr_b16 v[34:35], v6 offset:41984
    ds_read_b128 v[20:23], v2 offset:20480
    v_mfma_f32_32x32x16_bf16 v[208:223], v[56:59], v[44:47], v[208:223]
    ds_read_b64_tr_b16 v[28:29], v7 offset:32768
    ds_read_b64_tr_b16 v[30:31], v7 offset:33792
    v_mfma_f32_32x32x16_bf16 v[160:175], v[52:55], v[40:43], v[160:175]
    ds_read_b64_tr_b16 v[36:37], v7 offset:40960
    ds_read_b64_tr_b16 v[38:39], v7 offset:41984
    v_mfma_f32_16x16x32_bf16 v[96:99], v[88:91], v[48:51], v[96:99]
    v_mfma_f32_16x16x32_bf16 v[100:103], v[88:91], v[56:59], v[100:103]
    v_mfma_f32_32x32x16_bf16 v[224:239], v[60:63], v[40:43], v[224:239]
    v_mfma_f32_32x32x16_bf16 v[176:191], v[52:55], v[44:47], v[176:191]
    s_waitcnt lgkmcnt(0)
    s_nop 0
    v_mfma_f32_32x32x16_bf16 v[240:255], v[60:63], v[44:47], v[240:255]
    v_mfma_f32_32x32x16_bf16 v[128:143], v[24:27], v[16:19], v[128:143]
    ds_read_b128 v[40:43], v3 offset:16384
    ds_read_b64_tr_b16 v[48:49], v6 offset:36864
    v_mfma_f32_32x32x16_bf16 v[192:207], v[32:35], v[16:19], v[192:207]
    ds_read_b64_tr_b16 v[50:51], v6 offset:37888
    ds_read_b64_tr_b16 v[56:57], v6 offset:45056
    v_mfma_f32_32x32x16_bf16 v[144:159], v[24:27], v[20:23], v[144:159]
    ds_read_b64_tr_b16 v[58:59], v6 offset:46080
    ds_read_b128 v[44:47], v3 offset:20480
    v_mfma_f32_32x32x16_bf16 v[208:223], v[32:35], v[20:23], v[208:223]
    ds_read_b64_tr_b16 v[52:53], v7 offset:36864
    ds_read_b64_tr_b16 v[54:55], v7 offset:37888
    v_mfma_f32_32x32x16_bf16 v[160:175], v[28:31], v[16:19], v[160:175]
    ds_read_b64_tr_b16 v[60:61], v7 offset:45056
    ds_read_b64_tr_b16 v[62:63], v7 offset:46080
    v_mfma_f32_16x16x32_bf16 v[96:99], v[88:91], v[24:27], v[96:99]
    v_mfma_f32_16x16x32_bf16 v[100:103], v[88:91], v[32:35], v[100:103]
    v_mfma_f32_32x32x16_bf16 v[224:239], v[36:39], v[16:19], v[224:239]
    v_mfma_f32_32x32x16_bf16 v[176:191], v[28:31], v[20:23], v[176:191]
    s_waitcnt lgkmcnt(0)
    v_mfma_f32_32x32x16_bf16 v[240:255], v[36:39], v[20:23], v[240:255]
    s_barrier
    v_mfma_f32_32x32x16_bf16 v[128:143], v[48:51], v[40:43], v[128:143]
    ds_read_b128 v[16:19], v4 offset:16384
    ds_read_b64_tr_b16 v[24:25], v6 offset:49152
    v_mfma_f32_32x32x16_bf16 v[192:207], v[56:59], v[40:43], v[192:207]
    ds_read_b64_tr_b16 v[26:27], v6 offset:50176
    ds_read_b64_tr_b16 v[32:33], v6 offset:57344
    v_mfma_f32_32x32x16_bf16 v[144:159], v[48:51], v[44:47], v[144:159]
    ds_read_b64_tr_b16 v[34:35], v6 offset:58368
    ds_read_b128 v[20:23], v4 offset:20480
    v_mfma_f32_32x32x16_bf16 v[208:223], v[56:59], v[44:47], v[208:223]
    ds_read_b64_tr_b16 v[28:29], v7 offset:49152
    ds_read_b64_tr_b16 v[30:31], v7 offset:50176
    v_mfma_f32_32x32x16_bf16 v[160:175], v[52:55], v[40:43], v[160:175]
    ds_read_b64_tr_b16 v[36:37], v7 offset:57344
    ds_read_b64_tr_b16 v[38:39], v7 offset:58368
    v_mfma_f32_16x16x32_bf16 v[96:99], v[88:91], v[48:51], v[96:99]
    v_mfma_f32_16x16x32_bf16 v[100:103], v[88:91], v[56:59], v[100:103]
    v_mfma_f32_32x32x16_bf16 v[224:239], v[60:63], v[40:43], v[224:239]
    v_mfma_f32_32x32x16_bf16 v[176:191], v[52:55], v[44:47], v[176:191]
    s_waitcnt lgkmcnt(0)
    s_nop 0
    v_mfma_f32_32x32x16_bf16 v[240:255], v[60:63], v[44:47], v[240:255]
    v_mfma_f32_32x32x16_bf16 v[128:143], v[24:27], v[16:19], v[128:143]
    ds_read_b128 v[40:43], v5 offset:16384
    ds_read_b64_tr_b16 v[48:49], v6 offset:53248
    v_mfma_f32_32x32x16_bf16 v[192:207], v[32:35], v[16:19], v[192:207]
    ds_read_b64_tr_b16 v[50:51], v6 offset:54272
    ds_read_b64_tr_b16 v[56:57], v6 offset:61440
    v_mfma_f32_32x32x16_bf16 v[144:159], v[24:27], v[20:23], v[144:159]
    ds_read_b64_tr_b16 v[58:59], v6 offset:62464
    ds_read_b128 v[44:47], v5 offset:20480
    v_mfma_f32_32x32x16_bf16 v[208:223], v[32:35], v[20:23], v[208:223]
    ds_read_b64_tr_b16 v[52:53], v7 offset:53248
    ds_read_b64_tr_b16 v[54:55], v7 offset:54272
    v_mfma_f32_32x32x16_bf16 v[160:175], v[28:31], v[16:19], v[160:175]
    ds_read_b64_tr_b16 v[60:61], v7 offset:61440
    ds_read_b64_tr_b16 v[62:63], v7 offset:62464
    v_mfma_f32_16x16x32_bf16 v[96:99], v[88:91], v[24:27], v[96:99]
    v_mfma_f32_16x16x32_bf16 v[100:103], v[88:91], v[32:35], v[100:103]
    v_mfma_f32_32x32x16_bf16 v[224:239], v[36:39], v[16:19], v[224:239]
    v_mfma_f32_32x32x16_bf16 v[176:191], v[28:31], v[20:23], v[176:191]
    s_waitcnt lgkmcnt(0)
    v_mfma_f32_32x32x16_bf16 v[240:255], v[36:39], v[20:23], v[240:255]
    s_barrier
    v_mfma_f32_32x32x16_bf16 v[128:143], v[48:51], v[40:43], v[128:143]
    ds_read_b128 v[16:19], v2 offset:32768
    ds_read_b64_tr_b16 v[24:25], v6 offset:0
    v_mfma_f32_32x32x16_bf16 v[192:207], v[56:59], v[40:43], v[192:207]
    ds_read_b64_tr_b16 v[26:27], v6 offset:1024
    ds_read_b64_tr_b16 v[32:33], v6 offset:8192
    v_mfma_f32_32x32x16_bf16 v[144:159], v[48:51], v[44:47], v[144:159]
    ds_read_b64_tr_b16 v[34:35], v6 offset:9216
    ds_read_b128 v[20:23], v2 offset:36864
    v_mfma_f32_32x32x16_bf16 v[208:223], v[56:59], v[44:47], v[208:223]
    ds_read_b64_tr_b16 v[28:29], v7 offset:0
    ds_read_b64_tr_b16 v[30:31], v7 offset:1024
    v_mfma_f32_32x32x16_bf16 v[160:175], v[52:55], v[40:43], v[160:175]
    ds_read_b64_tr_b16 v[36:37], v7 offset:8192
    ds_read_b64_tr_b16 v[38:39], v7 offset:9216
    v_mfma_f32_16x16x32_bf16 v[96:99], v[88:91], v[48:51], v[96:99]
    v_mfma_f32_16x16x32_bf16 v[100:103], v[88:91], v[56:59], v[100:103]
    v_mfma_f32_32x32x16_bf16 v[224:239], v[60:63], v[40:43], v[224:239]
    v_mfma_f32_32x32x16_bf16 v[176:191], v[52:55], v[44:47], v[176:191]
    s_waitcnt lgkmcnt(0)
    s_nop 0
    v_mfma_f32_32x32x16_bf16 v[240:255], v[60:63], v[44:47], v[240:255]
    v_mfma_f32_32x32x16_bf16 v[128:143], v[24:27], v[16:19], v[128:143]
    ds_read_b128 v[40:43], v3 offset:32768
    ds_read_b64_tr_b16 v[48:49], v6 offset:4096
    v_mfma_f32_32x32x16_bf16 v[192:207], v[32:35], v[16:19], v[192:207]
    ds_read_b64_tr_b16 v[50:51], v6 offset:5120
    ds_read_b64_tr_b16 v[56:57], v6 offset:12288
    v_mfma_f32_32x32x16_bf16 v[144:159], v[24:27], v[20:23], v[144:159]
    ds_read_b64_tr_b16 v[58:59], v6 offset:13312
    ds_read_b128 v[44:47], v3 offset:36864
    v_mfma_f32_32x32x16_bf16 v[208:223], v[32:35], v[20:23], v[208:223]
    ds_read_b64_tr_b16 v[52:53], v7 offset:4096
    ds_read_b64_tr_b16 v[54:55], v7 offset:5120
    v_mfma_f32_32x32x16_bf16 v[160:175], v[28:31], v[16:19], v[160:175]
    ds_read_b64_tr_b16 v[60:61], v7 offset:12288
    ds_read_b64_tr_b16 v[62:63], v7 offset:13312
    v_mfma_f32_16x16x32_bf16 v[96:99], v[88:91], v[24:27], v[96:99]
    v_mfma_f32_16x16x32_bf16 v[100:103], v[88:91], v[32:35], v[100:103]
    v_mfma_f32_32x32x16_bf16 v[224:239], v[36:39], v[16:19], v[224:239]
    v_mfma_f32_32x32x16_bf16 v[176:191], v[28:31], v[20:23], v[176:191]
    s_waitcnt lgkmcnt(0)
    v_mfma_f32_32x32x16_bf16 v[240:255], v[36:39], v[20:23], v[240:255]
    s_barrier
    v_mfma_f32_32x32x16_bf16 v[128:143], v[48:51], v[40:43], v[128:143]
    ds_read_b128 v[16:19], v4 offset:32768
    ds_read_b64_tr_b16 v[24:25], v6 offset:16384
    v_mfma_f32_32x32x16_bf16 v[192:207], v[56:59], v[40:43], v[192:207]
    ds_read_b64_tr_b16 v[26:27], v6 offset:17408
    ds_read_b64_tr_b16 v[32:33], v6 offset:24576
    v_mfma_f32_32x32x16_bf16 v[144:159], v[48:51], v[44:47], v[144:159]
    ds_read_b64_tr_b16 v[34:35], v6 offset:25600
    ds_read_b128 v[20:23], v4 offset:36864
    v_mfma_f32_32x32x16_bf16 v[208:223], v[56:59], v[44:47], v[208:223]
    ds_read_b64_tr_b16 v[28:29], v7 offset:16384
    ds_read_b64_tr_b16 v[30:31], v7 offset:17408
    v_mfma_f32_32x32x16_bf16 v[160:175], v[52:55], v[40:43], v[160:175]
    ds_read_b64_tr_b16 v[36:37], v7 offset:24576
    ds_read_b64_tr_b16 v[38:39], v7 offset:25600
    v_mfma_f32_16x16x32_bf16 v[96:99], v[88:91], v[48:51], v[96:99]
    v_mfma_f32_16x16x32_bf16 v[100:103], v[88:91], v[56:59], v[100:103]
    v_mfma_f32_32x32x16_bf16 v[224:239], v[60:63], v[40:43], v[224:239]
    v_mfma_f32_32x32x16_bf16 v[176:191], v[52:55], v[44:47], v[176:191]
    s_waitcnt lgkmcnt(0)
    s_nop 0
    v_mfma_f32_32x32x16_bf16 v[240:255], v[60:63], v[44:47], v[240:255]
    v_mfma_f32_32x32x16_bf16 v[128:143], v[24:27], v[16:19], v[128:143]
    ds_read_b128 v[40:43], v5 offset:32768
    ds_read_b64_tr_b16 v[48:49], v6 offset:20480
    v_mfma_f32_32x32x16_bf16 v[192:207], v[32:35], v[16:19], v[192:207]
    ds_read_b64_tr_b16 v[50:51], v6 offset:21504
    ds_read_b64_tr_b16 v[56:57], v6 offset:28672
    v_mfma_f32_32x32x16_bf16 v[144:159], v[24:27], v[20:23], v[144:159]
    ds_read_b64_tr_b16 v[58:59], v6 offset:29696
    ds_read_b128 v[44:47], v5 offset:36864
    v_mfma_f32_32x32x16_bf16 v[208:223], v[32:35], v[20:23], v[208:223]
    ds_read_b64_tr_b16 v[52:53], v7 offset:20480
    ds_read_b64_tr_b16 v[54:55], v7 offset:21504
    v_mfma_f32_32x32x16_bf16 v[160:175], v[28:31], v[16:19], v[160:175]
    ds_read_b64_tr_b16 v[60:61], v7 offset:28672
    ds_read_b64_tr_b16 v[62:63], v7 offset:29696
    v_mfma_f32_16x16x32_bf16 v[96:99], v[88:91], v[24:27], v[96:99]
    v_mfma_f32_16x16x32_bf16 v[100:103], v[88:91], v[32:35], v[100:103]
    v_mfma_f32_32x32x16_bf16 v[224:239], v[36:39], v[16:19], v[224:239]
    v_mfma_f32_32x32x16_bf16 v[176:191], v[28:31], v[20:23], v[176:191]
    s_waitcnt lgkmcnt(0)
    v_mfma_f32_32x32x16_bf16 v[240:255], v[36:39], v[20:23], v[240:255]
    s_barrier
    v_mfma_f32_32x32x16_bf16 v[128:143], v[48:51], v[40:43], v[128:143]
    ds_read_b128 v[16:19], v2 offset:0
    ds_read_b64_tr_b16 v[24:25], v6 offset:32768
    v_mfma_f32_32x32x16_bf16 v[192:207], v[56:59], v[40:43], v[192:207]
    ds_read_b64_tr_b16 v[26:27], v6 offset:33792
    ds_read_b64_tr_b16 v[32:33], v6 offset:40960
    v_mfma_f32_32x32x16_bf16 v[144:159], v[48:51], v[44:47], v[144:159]
    ds_read_b64_tr_b16 v[34:35], v6 offset:41984
    ds_read_b128 v[20:23], v2 offset:4096
    v_mfma_f32_32x32x16_bf16 v[208:223], v[56:59], v[44:47], v[208:223]
    ds_read_b64_tr_b16 v[28:29], v7 offset:32768
    ds_read_b64_tr_b16 v[30:31], v7 offset:33792
    v_mfma_f32_32x32x16_bf16 v[160:175], v[52:55], v[40:43], v[160:175]
    ds_read_b64_tr_b16 v[36:37], v7 offset:40960
    ds_read_b64_tr_b16 v[38:39], v7 offset:41984
    v_mfma_f32_16x16x32_bf16 v[96:99], v[88:91], v[48:51], v[96:99]
    v_mfma_f32_16x16x32_bf16 v[100:103], v[88:91], v[56:59], v[100:103]
    v_mfma_f32_32x32x16_bf16 v[224:239], v[60:63], v[40:43], v[224:239]
    v_mfma_f32_32x32x16_bf16 v[176:191], v[52:55], v[44:47], v[176:191]
    s_waitcnt lgkmcnt(0)
    s_nop 0
    v_mfma_f32_32x32x16_bf16 v[240:255], v[60:63], v[44:47], v[240:255]
    v_mfma_f32_32x32x16_bf16 v[128:143], v[24:27], v[16:19], v[128:143]
    ds_read_b128 v[40:43], v3 offset:0
    ds_read_b64_tr_b16 v[48:49], v6 offset:36864
    v_mfma_f32_32x32x16_bf16 v[192:207], v[32:35], v[16:19], v[192:207]
    ds_read_b64_tr_b16 v[50:51], v6 offset:37888
    ds_read_b64_tr_b16 v[56:57], v6 offset:45056
    v_mfma_f32_32x32x16_bf16 v[144:159], v[24:27], v[20:23], v[144:159]
    ds_read_b64_tr_b16 v[58:59], v6 offset:46080
    ds_read_b128 v[44:47], v3 offset:4096
    v_mfma_f32_32x32x16_bf16 v[208:223], v[32:35], v[20:23], v[208:223]
    ds_read_b64_tr_b16 v[52:53], v7 offset:36864
    ds_read_b64_tr_b16 v[54:55], v7 offset:37888
    v_mfma_f32_32x32x16_bf16 v[160:175], v[28:31], v[16:19], v[160:175]
    ds_read_b64_tr_b16 v[60:61], v7 offset:45056
    ds_read_b64_tr_b16 v[62:63], v7 offset:46080
    v_mfma_f32_16x16x32_bf16 v[96:99], v[88:91], v[24:27], v[96:99]
    v_mfma_f32_16x16x32_bf16 v[100:103], v[88:91], v[32:35], v[100:103]
    v_mfma_f32_32x32x16_bf16 v[224:239], v[36:39], v[16:19], v[224:239]
    v_mfma_f32_32x32x16_bf16 v[176:191], v[28:31], v[20:23], v[176:191]
    s_waitcnt lgkmcnt(0)
    v_mfma_f32_32x32x16_bf16 v[240:255], v[36:39], v[20:23], v[240:255]
    s_barrier
    v_mfma_f32_32x32x16_bf16 v[128:143], v[48:51], v[40:43], v[128:143]
    ds_read_b128 v[16:19], v4 offset:0
    ds_read_b64_tr_b16 v[24:25], v6 offset:49152
    v_mfma_f32_32x32x16_bf16 v[192:207], v[56:59], v[40:43], v[192:207]
    ds_read_b64_tr_b16 v[26:27], v6 offset:50176
    ds_read_b64_tr_b16 v[32:33], v6 offset:57344
    v_mfma_f32_32x32x16_bf16 v[144:159], v[48:51], v[44:47], v[144:159]
    ds_read_b64_tr_b16 v[34:35], v6 offset:58368
    ds_read_b128 v[20:23], v4 offset:4096
    v_mfma_f32_32x32x16_bf16 v[208:223], v[56:59], v[44:47], v[208:223]
    ds_read_b64_tr_b16 v[28:29], v7 offset:49152
    ds_read_b64_tr_b16 v[30:31], v7 offset:50176
    v_mfma_f32_32x32x16_bf16 v[160:175], v[52:55], v[40:43], v[160:175]
    ds_read_b64_tr_b16 v[36:37], v7 offset:57344
    ds_read_b64_tr_b16 v[38:39], v7 offset:58368
    v_mfma_f32_16x16x32_bf16 v[96:99], v[88:91], v[48:51], v[96:99]
    v_mfma_f32_16x16x32_bf16 v[100:103], v[88:91], v[56:59], v[100:103]
    v_mfma_f32_32x32x16_bf16 v[224:239], v[60:63], v[40:43], v[224:239]
    v_mfma_f32_32x32x16_bf16 v[176:191], v[52:55], v[44:47], v[176:191]
    s_waitcnt lgkmcnt(0)
    s_nop 0
    v_mfma_f32_32x32x16_bf16 v[240:255], v[60:63], v[44:47], v[240:255]
    v_mfma_f32_32x32x16_bf16 v[128:143], v[24:27], v[16:19], v[128:143]
    ds_read_b128 v[40:43], v5 offset:0
    ds_read_b64_tr_b16 v[48:49], v6 offset:53248
    v_mfma_f32_32x32x16_bf16 v[192:207], v[32:35], v[16:19], v[192:207]
    ds_read_b64_tr_b16 v[50:51], v6 offset:54272
    ds_read_b64_tr_b16 v[56:57], v6 offset:61440
    v_mfma_f32_32x32x16_bf16 v[144:159], v[24:27], v[20:23], v[144:159]
    ds_read_b64_tr_b16 v[58:59], v6 offset:62464
    ds_read_b128 v[44:47], v5 offset:4096
    v_mfma_f32_32x32x16_bf16 v[208:223], v[32:35], v[20:23], v[208:223]
    ds_read_b64_tr_b16 v[52:53], v7 offset:53248
    ds_read_b64_tr_b16 v[54:55], v7 offset:54272
    v_mfma_f32_32x32x16_bf16 v[160:175], v[28:31], v[16:19], v[160:175]
    ds_read_b64_tr_b16 v[60:61], v7 offset:61440
    ds_read_b64_tr_b16 v[62:63], v7 offset:62464
    v_mfma_f32_16x16x32_bf16 v[96:99], v[88:91], v[24:27], v[96:99]
    v_mfma_f32_16x16x32_bf16 v[100:103], v[88:91], v[32:35], v[100:103]
    v_mfma_f32_32x32x16_bf16 v[224:239], v[36:39], v[16:19], v[224:239]
    v_mfma_f32_32x32x16_bf16 v[176:191], v[28:31], v[20:23], v[176:191]
    s_waitcnt lgkmcnt(0)
    v_mfma_f32_32x32x16_bf16 v[240:255], v[36:39], v[20:23], v[240:255]
    s_barrier
    v_mfma_f32_32x32x16_bf16 v[128:143], v[48:51], v[40:43], v[128:143]
    ds_read_b128 v[16:19], v2 offset:16384
    ds_read_b64_tr_b16 v[24:25], v6 offset:0
    v_mfma_f32_32x32x16_bf16 v[192:207], v[56:59], v[40:43], v[192:207]
    ds_read_b64_tr_b16 v[26:27], v6 offset:1024
    ds_read_b64_tr_b16 v[32:33], v6 offset:8192
    v_mfma_f32_32x32x16_bf16 v[144:159], v[48:51], v[44:47], v[144:159]
    ds_read_b64_tr_b16 v[34:35], v6 offset:9216
    ds_read_b128 v[20:23], v2 offset:20480
    v_mfma_f32_32x32x16_bf16 v[208:223], v[56:59], v[44:47], v[208:223]
    ds_read_b64_tr_b16 v[28:29], v7 offset:0
    ds_read_b64_tr_b16 v[30:31], v7 offset:1024
    v_mfma_f32_32x32x16_bf16 v[160:175], v[52:55], v[40:43], v[160:175]
    ds_read_b64_tr_b16 v[36:37], v7 offset:8192
    ds_read_b64_tr_b16 v[38:39], v7 offset:9216
    v_mfma_f32_16x16x32_bf16 v[96:99], v[88:91], v[48:51], v[96:99]
    v_mfma_f32_16x16x32_bf16 v[100:103], v[88:91], v[56:59], v[100:103]
    v_mfma_f32_32x32x16_bf16 v[224:239], v[60:63], v[40:43], v[224:239]
    v_mfma_f32_32x32x16_bf16 v[176:191], v[52:55], v[44:47], v[176:191]
    s_waitcnt lgkmcnt(0)
    s_nop 0
    v_mfma_f32_32x32x16_bf16 v[240:255], v[60:63], v[44:47], v[240:255]
    v_mfma_f32_32x32x16_bf16 v[128:143], v[24:27], v[16:19], v[128:143]
    ds_read_b128 v[40:43], v3 offset:16384
    ds_read_b64_tr_b16 v[48:49], v6 offset:4096
    v_mfma_f32_32x32x16_bf16 v[192:207], v[32:35], v[16:19], v[192:207]
    ds_read_b64_tr_b16 v[50:51], v6 offset:5120
    ds_read_b64_tr_b16 v[56:57], v6 offset:12288
    v_mfma_f32_32x32x16_bf16 v[144:159], v[24:27], v[20:23], v[144:159]
    ds_read_b64_tr_b16 v[58:59], v6 offset:13312
    ds_read_b128 v[44:47], v3 offset:20480
    v_mfma_f32_32x32x16_bf16 v[208:223], v[32:35], v[20:23], v[208:223]
    ds_read_b64_tr_b16 v[52:53], v7 offset:4096
    ds_read_b64_tr_b16 v[54:55], v7 offset:5120
    v_mfma_f32_32x32x16_bf16 v[160:175], v[28:31], v[16:19], v[160:175]
    ds_read_b64_tr_b16 v[60:61], v7 offset:12288
    ds_read_b64_tr_b16 v[62:63], v7 offset:13312
    v_mfma_f32_16x16x32_bf16 v[96:99], v[88:91], v[24:27], v[96:99]
    v_mfma_f32_16x16x32_bf16 v[100:103], v[88:91], v[32:35], v[100:103]
    v_mfma_f32_32x32x16_bf16 v[224:239], v[36:39], v[16:19], v[224:239]
    v_mfma_f32_32x32x16_bf16 v[176:191], v[28:31], v[20:23], v[176:191]
    s_waitcnt lgkmcnt(0)
    v_mfma_f32_32x32x16_bf16 v[240:255], v[36:39], v[20:23], v[240:255]
    s_barrier
    v_mfma_f32_32x32x16_bf16 v[128:143], v[48:51], v[40:43], v[128:143]
    ds_read_b128 v[16:19], v4 offset:16384
    ds_read_b64_tr_b16 v[24:25], v6 offset:16384
    v_mfma_f32_32x32x16_bf16 v[192:207], v[56:59], v[40:43], v[192:207]
    ds_read_b64_tr_b16 v[26:27], v6 offset:17408
    ds_read_b64_tr_b16 v[32:33], v6 offset:24576
    v_mfma_f32_32x32x16_bf16 v[144:159], v[48:51], v[44:47], v[144:159]
    ds_read_b64_tr_b16 v[34:35], v6 offset:25600
    ds_read_b128 v[20:23], v4 offset:20480
    v_mfma_f32_32x32x16_bf16 v[208:223], v[56:59], v[44:47], v[208:223]
    ds_read_b64_tr_b16 v[28:29], v7 offset:16384
    ds_read_b64_tr_b16 v[30:31], v7 offset:17408
    v_mfma_f32_32x32x16_bf16 v[160:175], v[52:55], v[40:43], v[160:175]
    ds_read_b64_tr_b16 v[36:37], v7 offset:24576
    ds_read_b64_tr_b16 v[38:39], v7 offset:25600
    v_mfma_f32_16x16x32_bf16 v[96:99], v[88:91], v[48:51], v[96:99]
    v_mfma_f32_16x16x32_bf16 v[100:103], v[88:91], v[56:59], v[100:103]
    v_mfma_f32_32x32x16_bf16 v[224:239], v[60:63], v[40:43], v[224:239]
    v_mfma_f32_32x32x16_bf16 v[176:191], v[52:55], v[44:47], v[176:191]
    s_waitcnt lgkmcnt(0)
    s_nop 0
    v_mfma_f32_32x32x16_bf16 v[240:255], v[60:63], v[44:47], v[240:255]
    v_mfma_f32_32x32x16_bf16 v[128:143], v[24:27], v[16:19], v[128:143]
    ds_read_b128 v[40:43], v5 offset:16384
    ds_read_b64_tr_b16 v[48:49], v6 offset:20480
    v_mfma_f32_32x32x16_bf16 v[192:207], v[32:35], v[16:19], v[192:207]
    ds_read_b64_tr_b16 v[50:51], v6 offset:21504
    ds_read_b64_tr_b16 v[56:57], v6 offset:28672
    v_mfma_f32_32x32x16_bf16 v[144:159], v[24:27], v[20:23], v[144:159]
    ds_read_b64_tr_b16 v[58:59], v6 offset:29696
    ds_read_b128 v[44:47], v5 offset:20480
    v_mfma_f32_32x32x16_bf16 v[208:223], v[32:35], v[20:23], v[208:223]
    ds_read_b64_tr_b16 v[52:53], v7 offset:20480
    ds_read_b64_tr_b16 v[54:55], v7 offset:21504
    v_mfma_f32_32x32x16_bf16 v[160:175], v[28:31], v[16:19], v[160:175]
    ds_read_b64_tr_b16 v[60:61], v7 offset:28672
    ds_read_b64_tr_b16 v[62:63], v7 offset:29696
    v_mfma_f32_16x16x32_bf16 v[96:99], v[88:91], v[24:27], v[96:99]
    v_mfma_f32_16x16x32_bf16 v[100:103], v[88:91], v[32:35], v[100:103]
    v_mfma_f32_32x32x16_bf16 v[224:239], v[36:39], v[16:19], v[224:239]
    v_mfma_f32_32x32x16_bf16 v[176:191], v[28:31], v[20:23], v[176:191]
    s_waitcnt lgkmcnt(0)
    v_mfma_f32_32x32x16_bf16 v[240:255], v[36:39], v[20:23], v[240:255]
    s_barrier
    v_mfma_f32_32x32x16_bf16 v[128:143], v[48:51], v[40:43], v[128:143]
    ds_read_b128 v[16:19], v2 offset:32768
    ds_read_b64_tr_b16 v[24:25], v6 offset:32768
    v_mfma_f32_32x32x16_bf16 v[192:207], v[56:59], v[40:43], v[192:207]
    ds_read_b64_tr_b16 v[26:27], v6 offset:33792
    ds_read_b64_tr_b16 v[32:33], v6 offset:40960
    v_mfma_f32_32x32x16_bf16 v[144:159], v[48:51], v[44:47], v[144:159]
    ds_read_b64_tr_b16 v[34:35], v6 offset:41984
    ds_read_b128 v[20:23], v2 offset:36864
    v_mfma_f32_32x32x16_bf16 v[208:223], v[56:59], v[44:47], v[208:223]
    ds_read_b64_tr_b16 v[28:29], v7 offset:32768
    ds_read_b64_tr_b16 v[30:31], v7 offset:33792
    v_mfma_f32_32x32x16_bf16 v[160:175], v[52:55], v[40:43], v[160:175]
    ds_read_b64_tr_b16 v[36:37], v7 offset:40960
    ds_read_b64_tr_b16 v[38:39], v7 offset:41984
    v_mfma_f32_16x16x32_bf16 v[96:99], v[88:91], v[48:51], v[96:99]
    v_mfma_f32_16x16x32_bf16 v[100:103], v[88:91], v[56:59], v[100:103]
    v_mfma_f32_32x32x16_bf16 v[224:239], v[60:63], v[40:43], v[224:239]
    v_mfma_f32_32x32x16_bf16 v[176:191], v[52:55], v[44:47], v[176:191]
    s_waitcnt lgkmcnt(0)
    s_nop 0
    v_mfma_f32_32x32x16_bf16 v[240:255], v[60:63], v[44:47], v[240:255]
    v_mfma_f32_32x32x16_bf16 v[128:143], v[24:27], v[16:19], v[128:143]
    ds_read_b128 v[40:43], v3 offset:32768
    ds_read_b64_tr_b16 v[48:49], v6 offset:36864
    v_mfma_f32_32x32x16_bf16 v[192:207], v[32:35], v[16:19], v[192:207]
    ds_read_b64_tr_b16 v[50:51], v6 offset:37888
    ds_read_b64_tr_b16 v[56:57], v6 offset:45056
    v_mfma_f32_32x32x16_bf16 v[144:159], v[24:27], v[20:23], v[144:159]
    ds_read_b64_tr_b16 v[58:59], v6 offset:46080
    ds_read_b128 v[44:47], v3 offset:36864
    v_mfma_f32_32x32x16_bf16 v[208:223], v[32:35], v[20:23], v[208:223]
    ds_read_b64_tr_b16 v[52:53], v7 offset:36864
    ds_read_b64_tr_b16 v[54:55], v7 offset:37888
    v_mfma_f32_32x32x16_bf16 v[160:175], v[28:31], v[16:19], v[160:175]
    ds_read_b64_tr_b16 v[60:61], v7 offset:45056
    ds_read_b64_tr_b16 v[62:63], v7 offset:46080
    v_mfma_f32_16x16x32_bf16 v[96:99], v[88:91], v[24:27], v[96:99]
    v_mfma_f32_16x16x32_bf16 v[100:103], v[88:91], v[32:35], v[100:103]
    v_mfma_f32_32x32x16_bf16 v[224:239], v[36:39], v[16:19], v[224:239]
    v_mfma_f32_32x32x16_bf16 v[176:191], v[28:31], v[20:23], v[176:191]
    s_waitcnt lgkmcnt(0)
    v_mfma_f32_32x32x16_bf16 v[240:255], v[36:39], v[20:23], v[240:255]
    s_barrier
    v_mfma_f32_32x32x16_bf16 v[128:143], v[48:51], v[40:43], v[128:143]
    ds_read_b128 v[16:19], v4 offset:32768
    ds_read_b64_tr_b16 v[24:25], v6 offset:49152
    v_mfma_f32_32x32x16_bf16 v[192:207], v[56:59], v[40:43], v[192:207]
    ds_read_b64_tr_b16 v[26:27], v6 offset:50176
    ds_read_b64_tr_b16 v[32:33], v6 offset:57344
    v_mfma_f32_32x32x16_bf16 v[144:159], v[48:51], v[44:47], v[144:159]
    ds_read_b64_tr_b16 v[34:35], v6 offset:58368
    ds_read_b128 v[20:23], v4 offset:36864
    v_mfma_f32_32x32x16_bf16 v[208:223], v[56:59], v[44:47], v[208:223]
    ds_read_b64_tr_b16 v[28:29], v7 offset:49152
    ds_read_b64_tr_b16 v[30:31], v7 offset:50176
    v_mfma_f32_32x32x16_bf16 v[160:175], v[52:55], v[40:43], v[160:175]
    ds_read_b64_tr_b16 v[36:37], v7 offset:57344
    ds_read_b64_tr_b16 v[38:39], v7 offset:58368
    v_mfma_f32_16x16x32_bf16 v[96:99], v[88:91], v[48:51], v[96:99]
    v_mfma_f32_16x16x32_bf16 v[100:103], v[88:91], v[56:59], v[100:103]
    s_lshl_b32 s61, s54, 1
    s_add_u32 s61, s61, s65
    s_lshl_b32 s61, s61, 9
    s_add_u32 s61, s61, 2097152
    v_lshrrev_b32 v9, 1, v8
    s_mov_b32 exec_hi, 0
    buffer_load_dword v80, v9, s[48:51], s61 offen offset:0 sc1
    buffer_load_dword v84, v9, s[48:51], s61 offen offset:256 sc1
    s_mov_b32 exec_hi, -1
    v_mfma_f32_32x32x16_bf16 v[224:239], v[60:63], v[40:43], v[224:239]
    v_mfma_f32_32x32x16_bf16 v[176:191], v[52:55], v[44:47], v[176:191]
    s_waitcnt lgkmcnt(0)
    s_nop 0
    v_mfma_f32_32x32x16_bf16 v[240:255], v[60:63], v[44:47], v[240:255]
    v_mfma_f32_32x32x16_bf16 v[128:143], v[24:27], v[16:19], v[128:143]
    ds_read_b128 v[40:43], v5 offset:32768
    ds_read_b64_tr_b16 v[48:49], v6 offset:53248
    v_mfma_f32_32x32x16_bf16 v[192:207], v[32:35], v[16:19], v[192:207]
    ds_read_b64_tr_b16 v[50:51], v6 offset:54272
    ds_read_b64_tr_b16 v[56:57], v6 offset:61440
    v_mfma_f32_32x32x16_bf16 v[144:159], v[24:27], v[20:23], v[144:159]
    ds_read_b64_tr_b16 v[58:59], v6 offset:62464
    ds_read_b128 v[44:47], v5 offset:36864
    v_mfma_f32_32x32x16_bf16 v[208:223], v[32:35], v[20:23], v[208:223]
    ds_read_b64_tr_b16 v[52:53], v7 offset:53248
    ds_read_b64_tr_b16 v[54:55], v7 offset:54272
    v_mfma_f32_32x32x16_bf16 v[160:175], v[28:31], v[16:19], v[160:175]
    ds_read_b64_tr_b16 v[60:61], v7 offset:61440
    ds_read_b64_tr_b16 v[62:63], v7 offset:62464
    v_mfma_f32_16x16x32_bf16 v[96:99], v[88:91], v[24:27], v[96:99]
    v_mfma_f32_16x16x32_bf16 v[100:103], v[88:91], v[32:35], v[100:103]
    v_mfma_f32_32x32x16_bf16 v[224:239], v[36:39], v[16:19], v[224:239]
    v_mfma_f32_32x32x16_bf16 v[176:191], v[28:31], v[20:23], v[176:191]
    s_waitcnt lgkmcnt(0)
    v_mfma_f32_32x32x16_bf16 v[240:255], v[36:39], v[20:23], v[240:255]
    s_barrier
    v_mfma_f32_32x32x16_bf16 v[128:143], v[48:51], v[40:43], v[128:143]
    ds_read_b128 v[16:19], v2 offset:0
    ds_read_b64_tr_b16 v[24:25], v6 offset:0
    v_mfma_f32_32x32x16_bf16 v[192:207], v[56:59], v[40:43], v[192:207]
    ds_read_b64_tr_b16 v[26:27], v6 offset:1024
    ds_read_b64_tr_b16 v[32:33], v6 offset:8192
    v_mfma_f32_32x32x16_bf16 v[144:159], v[48:51], v[44:47], v[144:159]
    ds_read_b64_tr_b16 v[34:35], v6 offset:9216
    ds_read_b128 v[20:23], v2 offset:4096
    v_mfma_f32_32x32x16_bf16 v[208:223], v[56:59], v[44:47], v[208:223]
    ds_read_b64_tr_b16 v[28:29], v7 offset:0
    ds_read_b64_tr_b16 v[30:31], v7 offset:1024
    v_mfma_f32_32x32x16_bf16 v[160:175], v[52:55], v[40:43], v[160:175]
    ds_read_b64_tr_b16 v[36:37], v7 offset:8192
    ds_read_b64_tr_b16 v[38:39], v7 offset:9216
    v_mfma_f32_16x16x32_bf16 v[96:99], v[88:91], v[48:51], v[96:99]
    v_mfma_f32_16x16x32_bf16 v[100:103], v[88:91], v[56:59], v[100:103]
    v_mfma_f32_32x32x16_bf16 v[224:239], v[60:63], v[40:43], v[224:239]
    v_mfma_f32_32x32x16_bf16 v[176:191], v[52:55], v[44:47], v[176:191]
    s_waitcnt lgkmcnt(0)
    s_nop 0
    v_mfma_f32_32x32x16_bf16 v[240:255], v[60:63], v[44:47], v[240:255]
    v_mfma_f32_32x32x16_bf16 v[128:143], v[24:27], v[16:19], v[128:143]
    ds_read_b128 v[40:43], v3 offset:0
    ds_read_b64_tr_b16 v[48:49], v6 offset:4096
    v_mfma_f32_32x32x16_bf16 v[192:207], v[32:35], v[16:19], v[192:207]
    ds_read_b64_tr_b16 v[50:51], v6 offset:5120
    ds_read_b64_tr_b16 v[56:57], v6 offset:12288
    v_mfma_f32_32x32x16_bf16 v[144:159], v[24:27], v[20:23], v[144:159]
    ds_read_b64_tr_b16 v[58:59], v6 offset:13312
    ds_read_b128 v[44:47], v3 offset:4096
    v_mfma_f32_32x32x16_bf16 v[208:223], v[32:35], v[20:23], v[208:223]
    ds_read_b64_tr_b16 v[52:53], v7 offset:4096
    ds_read_b64_tr_b16 v[54:55], v7 offset:5120
    v_mfma_f32_32x32x16_bf16 v[160:175], v[28:31], v[16:19], v[160:175]
    ds_read_b64_tr_b16 v[60:61], v7 offset:12288
    ds_read_b64_tr_b16 v[62:63], v7 offset:13312
    v_mfma_f32_16x16x32_bf16 v[96:99], v[88:91], v[24:27], v[96:99]
    v_mfma_f32_16x16x32_bf16 v[100:103], v[88:91], v[32:35], v[100:103]
    v_mfma_f32_32x32x16_bf16 v[224:239], v[36:39], v[16:19], v[224:239]
    v_mfma_f32_32x32x16_bf16 v[176:191], v[28:31], v[20:23], v[176:191]
    s_waitcnt lgkmcnt(0)
    v_mfma_f32_32x32x16_bf16 v[240:255], v[36:39], v[20:23], v[240:255]
    s_barrier
    v_mfma_f32_32x32x16_bf16 v[128:143], v[48:51], v[40:43], v[128:143]
    ds_read_b128 v[16:19], v4 offset:0
    ds_read_b64_tr_b16 v[24:25], v6 offset:16384
    v_mfma_f32_32x32x16_bf16 v[192:207], v[56:59], v[40:43], v[192:207]
    ds_read_b64_tr_b16 v[26:27], v6 offset:17408
    ds_read_b64_tr_b16 v[32:33], v6 offset:24576
    v_mfma_f32_32x32x16_bf16 v[144:159], v[48:51], v[44:47], v[144:159]
    ds_read_b64_tr_b16 v[34:35], v6 offset:25600
    ds_read_b128 v[20:23], v4 offset:4096
    v_mfma_f32_32x32x16_bf16 v[208:223], v[56:59], v[44:47], v[208:223]
    ds_read_b64_tr_b16 v[28:29], v7 offset:16384
    ds_read_b64_tr_b16 v[30:31], v7 offset:17408
    v_mfma_f32_32x32x16_bf16 v[160:175], v[52:55], v[40:43], v[160:175]
    ds_read_b64_tr_b16 v[36:37], v7 offset:24576
    ds_read_b64_tr_b16 v[38:39], v7 offset:25600
    v_mfma_f32_16x16x32_bf16 v[96:99], v[88:91], v[48:51], v[96:99]
    v_mfma_f32_16x16x32_bf16 v[100:103], v[88:91], v[56:59], v[100:103]
    v_mfma_f32_32x32x16_bf16 v[224:239], v[60:63], v[40:43], v[224:239]
    v_mfma_f32_32x32x16_bf16 v[176:191], v[52:55], v[44:47], v[176:191]
    s_waitcnt lgkmcnt(0)
    s_nop 0
    v_mfma_f32_32x32x16_bf16 v[240:255], v[60:63], v[44:47], v[240:255]
    v_mfma_f32_32x32x16_bf16 v[128:143], v[24:27], v[16:19], v[128:143]
    ds_read_b128 v[40:43], v5 offset:0
    ds_read_b64_tr_b16 v[48:49], v6 offset:20480
    v_mfma_f32_32x32x16_bf16 v[192:207], v[32:35], v[16:19], v[192:207]
    ds_read_b64_tr_b16 v[50:51], v6 offset:21504
    ds_read_b64_tr_b16 v[56:57], v6 offset:28672
    v_mfma_f32_32x32x16_bf16 v[144:159], v[24:27], v[20:23], v[144:159]
    ds_read_b64_tr_b16 v[58:59], v6 offset:29696
    ds_read_b128 v[44:47], v5 offset:4096
    v_mfma_f32_32x32x16_bf16 v[208:223], v[32:35], v[20:23], v[208:223]
    ds_read_b64_tr_b16 v[52:53], v7 offset:20480
    ds_read_b64_tr_b16 v[54:55], v7 offset:21504
    v_mfma_f32_32x32x16_bf16 v[160:175], v[28:31], v[16:19], v[160:175]
    ds_read_b64_tr_b16 v[60:61], v7 offset:28672
    ds_read_b64_tr_b16 v[62:63], v7 offset:29696
    v_mfma_f32_16x16x32_bf16 v[96:99], v[88:91], v[24:27], v[96:99]
    v_mfma_f32_16x16x32_bf16 v[100:103], v[88:91], v[32:35], v[100:103]
    v_mfma_f32_32x32x16_bf16 v[224:239], v[36:39], v[16:19], v[224:239]
    v_mfma_f32_32x32x16_bf16 v[176:191], v[28:31], v[20:23], v[176:191]
    s_waitcnt lgkmcnt(0)
    v_mfma_f32_32x32x16_bf16 v[240:255], v[36:39], v[20:23], v[240:255]
    v_mfma_f32_16x16x32_bf16 v[96:99], v[88:91], v[48:51], v[96:99]
    v_mfma_f32_16x16x32_bf16 v[100:103], v[88:91], v[56:59], v[100:103]
    v_mfma_f32_32x32x16_bf16 v[128:143], v[48:51], v[40:43], v[128:143]
    v_mfma_f32_32x32x16_bf16 v[192:207], v[56:59], v[40:43], v[192:207]
    v_mfma_f32_32x32x16_bf16 v[144:159], v[48:51], v[44:47], v[144:159]
    s_lshl_b32 s59, s3, 9
    v_lshrrev_b32 v9, 2, v8
    v_add_u32 v9, s59, v9
    v_add_u32 v2, 49152, v14
    v_xor_b32 v3, 64, v2
    v_cvt_pk_bf16_f32 v64, v96, v96
    v_lshlrev_b32 v64, 16, v64
    v_sub_f32 v10, v96, v64
    v_cvt_pk_bf16_f32 v64, v64, v10
    v_mfma_f32_32x32x16_bf16 v[208:223], v[56:59], v[44:47], v[208:223]
    v_cvt_pk_bf16_f32 v72, v100, v100
    v_lshlrev_b32 v72, 16, v72
    v_sub_f32 v10, v100, v72
    v_cvt_pk_bf16_f32 v72, v72, v10
    v_add_u32 v10, 42432, v9
    ds_write2st64_b32 v10, v64, v72 offset0:0 offset1:1
    v_xor_b32 v9, 512, v9
    v_mfma_f32_32x32x16_bf16 v[160:175], v[52:55], v[40:43], v[160:175]
    v_add_u32 v4, 98304, v14
    v_xor_b32 v5, 64, v4
    v_mfma_f32_32x32x16_bf16 v[224:239], v[60:63], v[40:43], v[224:239]
    s_waitcnt lgkmcnt(0)
    s_barrier
    ds_read_b32 v68, v9 offset:42432
    ds_read_b32 v76, v9 offset:42688
    v_mfma_f32_32x32x16_bf16 v[176:191], v[52:55], v[44:47], v[176:191]
    v_mfma_f32_32x32x16_bf16 v[240:255], v[60:63], v[44:47], v[240:255]
    s_waitcnt vmcnt(0)
    s_nop 0
    v_mfma_f32_32x32x16_bf16 v[128:143], v[64:67], v[80:83], v[128:143]
    ds_read_b64_tr_b16 v[104:105], v2 offset:16384
    ds_read_b64_tr_b16 v[106:107], v2 offset:17408
    v_mfma_f32_32x32x16_bf16 v[192:207], v[72:75], v[80:83], v[192:207]
    ds_read_b64_tr_b16 v[108:109], v3 offset:16384
    ds_read_b64_tr_b16 v[110:111], v3 offset:17408
    v_mfma_f32_32x32x16_bf16 v[144:159], v[64:67], v[84:87], v[144:159]
    ds_read_b64_tr_b16 v[112:113], v2 offset:18432
    ds_read_b64_tr_b16 v[114:115], v2 offset:19456
    v_mfma_f32_32x32x16_bf16 v[208:223], v[72:75], v[84:87], v[208:223]
    ds_read_b64_tr_b16 v[116:117], v3 offset:18432
    ds_read_b64_tr_b16 v[118:119], v3 offset:19456
    s_waitcnt lgkmcnt(8)
    s_nop 0
    v_mfma_f32_32x32x16_bf16 v[160:175], v[68:71], v[80:83], v[160:175]
    ds_read_b64_tr_b16 v[120:121], v4 offset:32768
    ds_read_b64_tr_b16 v[122:123], v4 offset:33792
    v_mfma_f32_32x32x16_bf16 v[224:239], v[76:79], v[80:83], v[224:239]
    ds_read_b64_tr_b16 v[124:125], v5 offset:32768
    ds_read_b64_tr_b16 v[126:127], v5 offset:33792
    v_mfma_f32_32x32x16_bf16 v[176:191], v[68:71], v[84:87], v[176:191]
    ds_read_b64_tr_b16 v[16:17], v4 offset:34816
    ds_read_b64_tr_b16 v[18:19], v4 offset:35840
    v_mfma_f32_32x32x16_bf16 v[240:255], v[76:79], v[84:87], v[240:255]
    ds_read_b64_tr_b16 v[20:21], v5 offset:34816
    ds_read_b64_tr_b16 v[22:23], v5 offset:35840
    s_setprio 3
    v_max_f32 v128, 0, v128
    v_max_f32 v129, 0, v129
    v_max_f32 v130, 0, v130
    v_max_f32 v131, 0, v131
    v_max_f32 v132, 0, v132
    v_max_f32 v133, 0, v133
    v_max_f32 v134, 0, v134
    v_max_f32 v135, 0, v135
    v_mul_f32 v128, v128, v192
    v_mul_f32 v129, v129, v193
    v_mul_f32 v130, v130, v194
    v_mul_f32 v131, v131, v195
    v_mul_f32 v132, v132, v196
    v_mul_f32 v133, v133, v197
    v_mul_f32 v134, v134, v198
    v_mul_f32 v135, v135, v199
    v_cvt_pk_bf16_f32 v128, v128, v129
    v_cvt_pk_bf16_f32 v129, v130, v131
    v_cvt_pk_bf16_f32 v130, v132, v133
    v_cvt_pk_bf16_f32 v131, v134, v135
    buffer_store_dwordx4 v[128:131], v8, s[48:51], s78 offen offset:0 sc1
    v_max_f32 v136, 0, v136
    v_max_f32 v137, 0, v137
    v_max_f32 v138, 0, v138
    v_max_f32 v139, 0, v139
    v_max_f32 v140, 0, v140
    v_max_f32 v141, 0, v141
    v_max_f32 v142, 0, v142
    v_max_f32 v143, 0, v143
    v_mul_f32 v136, v136, v200
    v_mul_f32 v137, v137, v201
    v_mul_f32 v138, v138, v202
    v_mul_f32 v139, v139, v203
    v_mul_f32 v140, v140, v204
    v_mul_f32 v141, v141, v205
    v_mul_f32 v142, v142, v206
    v_mul_f32 v143, v143, v207
    v_cvt_pk_bf16_f32 v136, v136, v137
    v_cvt_pk_bf16_f32 v137, v138, v139
    v_cvt_pk_bf16_f32 v138, v140, v141
    v_cvt_pk_bf16_f32 v139, v142, v143
    buffer_store_dwordx4 v[136:139], v8, s[48:51], s78 offen offset:1024 sc1
    v_max_f32 v144, 0, v144
    v_max_f32 v145, 0, v145
    v_max_f32 v146, 0, v146
    v_max_f32 v147, 0, v147
    v_max_f32 v148, 0, v148
    v_max_f32 v149, 0, v149
    v_max_f32 v150, 0, v150
    v_max_f32 v151, 0, v151
    v_mul_f32 v144, v144, v208
    v_mul_f32 v145, v145, v209
    v_mul_f32 v146, v146, v210
    v_mul_f32 v147, v147, v211
    v_mul_f32 v148, v148, v212
    v_mul_f32 v149, v149, v213
    v_mul_f32 v150, v150, v214
    v_mul_f32 v151, v151, v215
    v_cvt_pk_bf16_f32 v144, v144, v145
    v_cvt_pk_bf16_f32 v145, v146, v147
    v_cvt_pk_bf16_f32 v146, v148, v149
    v_cvt_pk_bf16_f32 v147, v150, v151
    buffer_store_dwordx4 v[144:147], v8, s[48:51], s80 offen offset:0 sc1
    v_max_f32 v152, 0, v152
    v_max_f32 v153, 0, v153
    v_max_f32 v154, 0, v154
    v_max_f32 v155, 0, v155
    v_max_f32 v156, 0, v156
    v_max_f32 v157, 0, v157
    v_max_f32 v158, 0, v158
    v_max_f32 v159, 0, v159
    v_mul_f32 v152, v152, v216
    v_mul_f32 v153, v153, v217
    v_mul_f32 v154, v154, v218
    v_mul_f32 v155, v155, v219
    v_mul_f32 v156, v156, v220
    v_mul_f32 v157, v157, v221
    v_mul_f32 v158, v158, v222
    v_mul_f32 v159, v159, v223
    v_cvt_pk_bf16_f32 v152, v152, v153
    v_cvt_pk_bf16_f32 v153, v154, v155
    v_cvt_pk_bf16_f32 v154, v156, v157
    v_cvt_pk_bf16_f32 v155, v158, v159
    buffer_store_dwordx4 v[152:155], v8, s[48:51], s80 offen offset:1024 sc1
    v_max_f32 v160, 0, v160
    v_max_f32 v161, 0, v161
    v_max_f32 v162, 0, v162
    v_max_f32 v163, 0, v163
    v_max_f32 v164, 0, v164
    v_max_f32 v165, 0, v165
    v_max_f32 v166, 0, v166
    v_max_f32 v167, 0, v167
    v_mul_f32 v160, v160, v224
    v_mul_f32 v161, v161, v225
    v_mul_f32 v162, v162, v226
    v_mul_f32 v163, v163, v227
    v_mul_f32 v164, v164, v228
    v_mul_f32 v165, v165, v229
    v_mul_f32 v166, v166, v230
    v_mul_f32 v167, v167, v231
    v_cvt_pk_bf16_f32 v160, v160, v161
    v_cvt_pk_bf16_f32 v161, v162, v163
    v_cvt_pk_bf16_f32 v162, v164, v165
    v_cvt_pk_bf16_f32 v163, v166, v167
    buffer_store_dwordx4 v[160:163], v8, s[48:51], s79 offen offset:0 sc1
    v_max_f32 v168, 0, v168
    v_max_f32 v169, 0, v169
    v_max_f32 v170, 0, v170
    v_max_f32 v171, 0, v171
    v_max_f32 v172, 0, v172
    v_max_f32 v173, 0, v173
    v_max_f32 v174, 0, v174
    v_max_f32 v175, 0, v175
    v_mul_f32 v168, v168, v232
    v_mul_f32 v169, v169, v233
    v_mul_f32 v170, v170, v234
    v_mul_f32 v171, v171, v235
    v_mul_f32 v172, v172, v236
    v_mul_f32 v173, v173, v237
    v_mul_f32 v174, v174, v238
    v_mul_f32 v175, v175, v239
    v_cvt_pk_bf16_f32 v168, v168, v169
    v_cvt_pk_bf16_f32 v169, v170, v171
    v_cvt_pk_bf16_f32 v170, v172, v173
    v_cvt_pk_bf16_f32 v171, v174, v175
    buffer_store_dwordx4 v[168:171], v8, s[48:51], s79 offen offset:1024 sc1
    v_max_f32 v176, 0, v176
    v_max_f32 v177, 0, v177
    v_max_f32 v178, 0, v178
    v_max_f32 v179, 0, v179
    v_max_f32 v180, 0, v180
    v_max_f32 v181, 0, v181
    v_max_f32 v182, 0, v182
    v_max_f32 v183, 0, v183
    v_mul_f32 v176, v176, v240
    v_mul_f32 v177, v177, v241
    v_mul_f32 v178, v178, v242
    v_mul_f32 v179, v179, v243
    v_mul_f32 v180, v180, v244
    v_mul_f32 v181, v181, v245
    v_mul_f32 v182, v182, v246
    v_mul_f32 v183, v183, v247
    v_cvt_pk_bf16_f32 v176, v176, v177
    v_cvt_pk_bf16_f32 v177, v178, v179
    v_cvt_pk_bf16_f32 v178, v180, v181
    v_cvt_pk_bf16_f32 v179, v182, v183
    buffer_store_dwordx4 v[176:179], v8, s[48:51], s81 offen offset:0 sc1
    v_max_f32 v184, 0, v184
    v_max_f32 v185, 0, v185
    v_max_f32 v186, 0, v186
    v_max_f32 v187, 0, v187
    v_max_f32 v188, 0, v188
    v_max_f32 v189, 0, v189
    v_max_f32 v190, 0, v190
    v_max_f32 v191, 0, v191
    v_mul_f32 v184, v184, v248
    v_mul_f32 v185, v185, v249
    v_mul_f32 v186, v186, v250
    v_mul_f32 v187, v187, v251
    v_mul_f32 v188, v188, v252
    v_mul_f32 v189, v189, v253
    v_mul_f32 v190, v190, v254
    v_mul_f32 v191, v191, v255
    v_cvt_pk_bf16_f32 v184, v184, v185
    v_cvt_pk_bf16_f32 v185, v186, v187
    v_cvt_pk_bf16_f32 v186, v188, v189
    v_cvt_pk_bf16_f32 v187, v190, v191
    buffer_store_dwordx4 v[184:187], v8, s[48:51], s81 offen offset:1024 sc1
    s_waitcnt lgkmcnt(0)
    s_mov_b32 s68, 0
L_sl13:
    ds_read_b32 v9, v13 offset:47840
    s_add_u32 s68, s68, 1
    s_waitcnt lgkmcnt(0)
    v_cmp_le_u32 vcc, 1, v9
    s_cbranch_vccnz L_sd14
    s_cmp_lt_u32 s68, 1048576
    s_cbranch_scc1 L_sl13
L_sd14:
    ds_read_b64_tr_b16 v[24:25], v4 offset:49152
    ds_read_b64_tr_b16 v[26:27], v4 offset:50176
    ds_read_b64_tr_b16 v[28:29], v5 offset:49152
    ds_read_b64_tr_b16 v[30:31], v5 offset:50176
    ds_read_b64_tr_b16 v[32:33], v4 offset:51200
    ds_read_b64_tr_b16 v[34:35], v4 offset:52224
    ds_read_b64_tr_b16 v[36:37], v5 offset:51200
    ds_read_b64_tr_b16 v[38:39], v5 offset:52224
    ds_read_b64_tr_b16 v[40:41], v2 offset:32768
    ds_read_b64_tr_b16 v[42:43], v2 offset:33792
    ds_read_b64_tr_b16 v[44:45], v3 offset:32768
    ds_read_b64_tr_b16 v[46:47], v3 offset:33792
    ds_read_b64_tr_b16 v[48:49], v2 offset:34816
    ds_read_b64_tr_b16 v[50:51], v2 offset:35840
    ds_read_b64_tr_b16 v[52:53], v3 offset:34816
    ds_read_b64_tr_b16 v[54:55], v3 offset:35840
    ds_read_b64_tr_b16 v[56:57], v4 offset:0
    ds_read_b64_tr_b16 v[58:59], v4 offset:1024
    ds_read_b64_tr_b16 v[60:61], v5 offset:0
    ds_read_b64_tr_b16 v[62:63], v5 offset:1024
    ds_read_b64_tr_b16 v[64:65], v4 offset:2048
    ds_read_b64_tr_b16 v[66:67], v4 offset:3072
    ds_read_b64_tr_b16 v[68:69], v5 offset:2048
    ds_read_b64_tr_b16 v[70:71], v5 offset:3072
    s_add_u32 m0, s76, 65536
    s_add_u32 s74, s74, 7168
    buffer_load_dwordx4 v12, s[44:47], s74 offen lds
    s_add_u32 m0, s76, 66560
    s_add_u32 s74, s74, 7168
    buffer_load_dwordx4 v12, s[44:47], s74 offen lds
    s_add_u32 m0, s76, 67584
    s_add_u32 s74, s74, 7168
    buffer_load_dwordx4 v12, s[44:47], s74 offen lds
    s_add_u32 m0, s76, 68608
    s_add_u32 s74, s74, 7168
    buffer_load_dwordx4 v12, s[44:47], s74 offen lds
    s_mov_b32 s68, 0
L_sl15:
    ds_read_b32 v9, v13 offset:47840
    s_add_u32 s68, s68, 1
    s_waitcnt lgkmcnt(0)
    v_cmp_le_u32 vcc, 2, v9
    s_cbranch_vccnz L_sd16
    s_cmp_lt_u32 s68, 1048576
    s_cbranch_scc1 L_sl15
L_sd16:
    ds_read_b64_tr_b16 v[72:73], v4 offset:16384
    ds_read_b64_tr_b16 v[74:75], v4 offset:17408
    ds_read_b64_tr_b16 v[76:77], v5 offset:16384
    ds_read_b64_tr_b16 v[78:79], v5 offset:17408
    ds_read_b64_tr_b16 v[80:81], v4 offset:18432
    ds_read_b64_tr_b16 v[82:83], v4 offset:19456
    ds_read_b64_tr_b16 v[84:85], v5 offset:18432
    ds_read_b64_tr_b16 v[86:87], v5 offset:19456
    ds_read_b64_tr_b16 v[88:89], v2 offset:0
    ds_read_b64_tr_b16 v[90:91], v2 offset:1024
    ds_read_b64_tr_b16 v[92:93], v3 offset:0
    ds_read_b64_tr_b16 v[94:95], v3 offset:1024
    ds_read_b64_tr_b16 v[96:97], v2 offset:2048
    ds_read_b64_tr_b16 v[98:99], v2 offset:3072
    ds_read_b64_tr_b16 v[100:101], v3 offset:2048
    ds_read_b64_tr_b16 v[102:103], v3 offset:3072
    s_add_u32 m0, s76, 131072
    s_add_u32 s74, s74, 7168
    buffer_load_dwordx4 v12, s[44:47], s74 offen lds
    s_add_u32 m0, s76, 132096
    s_add_u32 s74, s74, 7168
    buffer_load_dwordx4 v12, s[44:47], s74 offen lds
    s_add_u32 m0, s76, 133120
    s_add_u32 s74, s74, 7168
    buffer_load_dwordx4 v12, s[44:47], s74 offen lds
    s_add_u32 m0, s76, 134144
    s_add_u32 s74, s74, 7168
    buffer_load_dwordx4 v12, s[44:47], s74 offen lds
    s_waitcnt lgkmcnt(0)
    s_mov_b32 s86, 1
    s_waitcnt vmcnt(8)
    s_nop 0
    s_atomic_add s86, s[16:17], 0
    s_add_u32 m0, s76, 147456
    s_add_u32 s74, s74, 7168
    buffer_load_dwordx4 v12, s[44:47], s74 offen lds
    s_add_u32 m0, s76, 148480
    s_add_u32 s74, s74, 7168
    buffer_load_dwordx4 v12, s[44:47], s74 offen lds
    s_add_u32 m0, s76, 149504
    s_add_u32 s74, s74, 7168
    buffer_load_dwordx4 v12, s[44:47], s74 offen lds
    s_add_u32 m0, s76, 150528
    s_add_u32 s74, s74, 7168
    buffer_load_dwordx4 v12, s[44:47], s74 offen lds
    s_add_u32 m0, s76, 81920
    s_add_u32 s74, s74, 7168
    buffer_load_dwordx4 v12, s[44:47], s74 offen lds
    s_add_u32 m0, s76, 82944
    s_add_u32 s74, s74, 7168
    buffer_load_dwordx4 v12, s[44:47], s74 offen lds
    s_add_u32 m0, s76, 83968
    s_add_u32 s74, s74, 7168
    buffer_load_dwordx4 v12, s[44:47], s74 offen lds
    s_add_u32 m0, s76, 84992
    s_add_u32 s74, s74, 7168
    buffer_load_dwordx4 v12, s[44:47], s74 offen lds
    s_add_u32 m0, s76, 98304
    s_add_u32 s74, s74, 7168
    buffer_load_dwordx4 v12, s[44:47], s74 offen lds
    s_add_u32 m0, s76, 99328
    s_add_u32 s74, s74, 7168
    buffer_load_dwordx4 v12, s[44:47], s74 offen lds
    s_add_u32 m0, s76, 100352
    s_add_u32 s74, s74, 7168
    buffer_load_dwordx4 v12, s[44:47], s74 offen lds
    s_add_u32 m0, s76, 101376
    s_add_u32 s74, s74, 7168
    buffer_load_dwordx4 v12, s[44:47], s74 offen lds
    s_mov_b32 s85, 0
    s_nop 0
    s_atomic_add s85, s[30:31], s77 glc
    s_add_u32 m0, s76, 114688
    s_add_u32 s74, s74, 7168
    buffer_load_dwordx4 v12, s[44:47], s74 offen lds
    s_add_u32 m0, s76, 115712
    s_add_u32 s74, s74, 7168
    buffer_load_dwordx4 v12, s[44:47], s74 offen lds
    s_add_u32 m0, s76, 116736
    s_add_u32 s74, s74, 7168
    buffer_load_dwordx4 v12, s[44:47], s74 offen lds
    s_add_u32 m0, s76, 117760
    s_add_u32 s74, s74, 7168
    buffer_load_dwordx4 v12, s[44:47], s74 offen lds
    s_add_u32 m0, s76, 49152
    s_add_u32 s74, s74, 7168
    buffer_load_dwordx4 v12, s[44:47], s74 offen lds
    s_add_u32 m0, s76, 50176
    s_add_u32 s74, s74, 7168
    buffer_load_dwordx4 v12, s[44:47], s74 offen lds
    s_add_u32 m0, s76, 51200
    s_add_u32 s74, s74, 7168
    buffer_load_dwordx4 v12, s[44:47], s74 offen lds
    s_add_u32 m0, s76, 52224
    s_add_u32 s74, s74, 7168
    buffer_load_dwordx4 v12, s[44:47], s74 offen lds
    s_mul_i32 s78, s56, 229376
    s_mul_i32 s59, s3, 28672
    s_add_u32 s78, s78, s59
    s_add_u32 s78, s78, 4194304
    s_add_u32 s79, s78, 14336
    s_add_u32 s59, s76, 98304
    v_lshl_add_u32 v6, v1, 2, s59
    v_xor_b32 v7, 16, v6
    v_xor_b32 v11, 128, v6
    v_xor_b32 v14, 144, v6
    s_mov_b32 s68, 0
    s_branch L_qc19
L_ql17:
    s_mov_b32 s85, 0
    s_atomic_add s85, s[30:31], s77 glc
L_qc19:
    s_waitcnt lgkmcnt(0)
    s_cmp_ge_u32 s85, 7
    s_cbranch_scc1 L_qd18
    s_add_u32 s68, s68, 1
    s_sleep 2
    s_cmp_lt_u32 s68, 65536
    s_cbranch_scc1 L_ql17
L_qd18:
    s_add_u32 s80, s78, 0
    s_add_u32 s81, s80, 114688
    buffer_load_dwordx4 v[128:131], v8, s[48:51], s80 offen offset:0 sc1
    buffer_load_dwordx4 v[132:135], v8, s[48:51], s81 offen offset:0 sc1
    buffer_load_dwordx4 v[136:139], v8, s[48:51], s80 offen offset:1024 sc1
    buffer_load_dwordx4 v[140:143], v8, s[48:51], s81 offen offset:1024 sc1
    buffer_load_dwordx4 v[144:147], v8, s[48:51], s80 offen offset:2048 sc1
    buffer_load_dwordx4 v[148:151], v8, s[48:51], s81 offen offset:2048 sc1
    buffer_load_dwordx4 v[152:155], v8, s[48:51], s80 offen offset:3072 sc1
    buffer_load_dwordx4 v[156:159], v8, s[48:51], s81 offen offset:3072 sc1
    s_add_u32 s80, s78, 4096
    s_add_u32 s81, s80, 114688
    buffer_load_dwordx4 v[160:163], v8, s[48:51], s80 offen offset:0 sc1
    buffer_load_dwordx4 v[164:167], v8, s[48:51], s81 offen offset:0 sc1
    buffer_load_dwordx4 v[168:171], v8, s[48:51], s80 offen offset:1024 sc1
    buffer_load_dwordx4 v[172:175], v8, s[48:51], s81 offen offset:1024 sc1
    s_setprio 0
    s_waitcnt vmcnt(10)
    v_mfma_f32_32x32x16_bf16 v[192:207], v[128:131], v[104:107], 0
    v_mfma_f32_32x32x16_bf16 v[208:223], v[128:131], v[108:111], 0
    v_mfma_f32_32x32x16_bf16 v[224:239], v[132:135], v[104:107], 0
    v_mfma_f32_32x32x16_bf16 v[240:255], v[132:135], v[108:111], 0
    buffer_load_dwordx4 v[128:131], v8, s[48:51], s80 offen offset:2048 sc1
    buffer_load_dwordx4 v[132:135], v8, s[48:51], s81 offen offset:2048 sc1
    s_waitcnt vmcnt(10)
    v_mfma_f32_32x32x16_bf16 v[192:207], v[136:139], v[112:115], v[192:207]
    v_mfma_f32_32x32x16_bf16 v[208:223], v[136:139], v[116:119], v[208:223]
    v_mfma_f32_32x32x16_bf16 v[224:239], v[140:143], v[112:115], v[224:239]
    v_mfma_f32_32x32x16_bf16 v[240:255], v[140:143], v[116:119], v[240:255]
    buffer_load_dwordx4 v[136:139], v8, s[48:51], s80 offen offset:3072 sc1
    buffer_load_dwordx4 v[140:143], v8, s[48:51], s81 offen offset:3072 sc1
    s_waitcnt vmcnt(10)
    v_mfma_f32_32x32x16_bf16 v[192:207], v[144:147], v[120:123], v[192:207]
    v_mfma_f32_32x32x16_bf16 v[208:223], v[144:147], v[124:127], v[208:223]
    v_mfma_f32_32x32x16_bf16 v[224:239], v[148:151], v[120:123], v[224:239]
    v_mfma_f32_32x32x16_bf16 v[240:255], v[148:151], v[124:127], v[240:255]
    s_add_u32 s80, s78, 8192
    s_add_u32 s81, s80, 114688
    buffer_load_dwordx4 v[144:147], v8, s[48:51], s80 offen offset:0 sc1
    buffer_load_dwordx4 v[148:151], v8, s[48:51], s81 offen offset:0 sc1
    s_waitcnt vmcnt(10)
    v_mfma_f32_32x32x16_bf16 v[192:207], v[152:155], v[16:19], v[192:207]
    v_mfma_f32_32x32x16_bf16 v[208:223], v[152:155], v[20:23], v[208:223]
    v_mfma_f32_32x32x16_bf16 v[224:239], v[156:159], v[16:19], v[224:239]
    v_mfma_f32_32x32x16_bf16 v[240:255], v[156:159], v[20:23], v[240:255]
    buffer_load_dwordx4 v[152:155], v8, s[48:51], s80 offen offset:1024 sc1
    buffer_load_dwordx4 v[156:159], v8, s[48:51], s81 offen offset:1024 sc1
    s_waitcnt vmcnt(10)
    v_mfma_f32_32x32x16_bf16 v[192:207], v[160:163], v[24:27], v[192:207]
    v_mfma_f32_32x32x16_bf16 v[208:223], v[160:163], v[28:31], v[208:223]
    v_mfma_f32_32x32x16_bf16 v[224:239], v[164:167], v[24:27], v[224:239]
    v_mfma_f32_32x32x16_bf16 v[240:255], v[164:167], v[28:31], v[240:255]
    buffer_load_dwordx4 v[160:163], v8, s[48:51], s80 offen offset:2048 sc1
    buffer_load_dwordx4 v[164:167], v8, s[48:51], s81 offen offset:2048 sc1
    s_waitcnt vmcnt(10)
    v_mfma_f32_32x32x16_bf16 v[192:207], v[168:171], v[32:35], v[192:207]
    v_mfma_f32_32x32x16_bf16 v[208:223], v[168:171], v[36:39], v[208:223]
    v_mfma_f32_32x32x16_bf16 v[224:239], v[172:175], v[32:35], v[224:239]
    v_mfma_f32_32x32x16_bf16 v[240:255], v[172:175], v[36:39], v[240:255]
    buffer_load_dwordx4 v[168:171], v8, s[48:51], s80 offen offset:3072 sc1
    buffer_load_dwordx4 v[172:175], v8, s[48:51], s81 offen offset:3072 sc1
    s_waitcnt vmcnt(10)
    v_mfma_f32_32x32x16_bf16 v[192:207], v[128:131], v[40:43], v[192:207]
    v_mfma_f32_32x32x16_bf16 v[208:223], v[128:131], v[44:47], v[208:223]
    v_mfma_f32_32x32x16_bf16 v[224:239], v[132:135], v[40:43], v[224:239]
    v_mfma_f32_32x32x16_bf16 v[240:255], v[132:135], v[44:47], v[240:255]
    s_add_u32 s80, s78, 12288
    s_add_u32 s81, s80, 114688
    buffer_load_dwordx4 v[128:131], v8, s[48:51], s80 offen offset:0 sc1
    buffer_load_dwordx4 v[132:135], v8, s[48:51], s81 offen offset:0 sc1
    s_waitcnt vmcnt(10)
    v_mfma_f32_32x32x16_bf16 v[192:207], v[136:139], v[48:51], v[192:207]
    v_mfma_f32_32x32x16_bf16 v[208:223], v[136:139], v[52:55], v[208:223]
    v_mfma_f32_32x32x16_bf16 v[224:239], v[140:143], v[48:51], v[224:239]
    v_mfma_f32_32x32x16_bf16 v[240:255], v[140:143], v[52:55], v[240:255]
    buffer_load_dwordx4 v[136:139], v8, s[48:51], s80 offen offset:1024 sc1
    buffer_load_dwordx4 v[140:143], v8, s[48:51], s81 offen offset:1024 sc1
    s_waitcnt vmcnt(10)
    v_mfma_f32_32x32x16_bf16 v[192:207], v[144:147], v[56:59], v[192:207]
    v_mfma_f32_32x32x16_bf16 v[208:223], v[144:147], v[60:63], v[208:223]
    v_mfma_f32_32x32x16_bf16 v[224:239], v[148:151], v[56:59], v[224:239]
    v_mfma_f32_32x32x16_bf16 v[240:255], v[148:151], v[60:63], v[240:255]
    s_add_u32 s80, s79, 0
    s_add_u32 s81, s80, 114688
    buffer_load_dwordx4 v[144:147], v8, s[48:51], s80 offen offset:0 sc1
    buffer_load_dwordx4 v[148:151], v8, s[48:51], s81 offen offset:0 sc1
    s_waitcnt vmcnt(10)
    v_mfma_f32_32x32x16_bf16 v[192:207], v[152:155], v[64:67], v[192:207]
    v_mfma_f32_32x32x16_bf16 v[208:223], v[152:155], v[68:71], v[208:223]
    v_mfma_f32_32x32x16_bf16 v[224:239], v[156:159], v[64:67], v[224:239]
    v_mfma_f32_32x32x16_bf16 v[240:255], v[156:159], v[68:71], v[240:255]
    buffer_load_dwordx4 v[152:155], v8, s[48:51], s80 offen offset:1024 sc1
    buffer_load_dwordx4 v[156:159], v8, s[48:51], s81 offen offset:1024 sc1
    s_waitcnt vmcnt(10)
    v_mfma_f32_32x32x16_bf16 v[192:207], v[160:163], v[72:75], v[192:207]
    v_mfma_f32_32x32x16_bf16 v[208:223], v[160:163], v[76:79], v[208:223]
    v_mfma_f32_32x32x16_bf16 v[224:239], v[164:167], v[72:75], v[224:239]
    v_mfma_f32_32x32x16_bf16 v[240:255], v[164:167], v[76:79], v[240:255]
    buffer_load_dwordx4 v[160:163], v8, s[48:51], s80 offen offset:2048 sc1
    buffer_load_dwordx4 v[164:167], v8, s[48:51], s81 offen offset:2048 sc1
    s_waitcnt vmcnt(10)
    v_mfma_f32_32x32x16_bf16 v[192:207], v[168:171], v[80:83], v[192:207]
    v_mfma_f32_32x32x16_bf16 v[208:223], v[168:171], v[84:87], v[208:223]
    v_mfma_f32_32x32x16_bf16 v[224:239], v[172:175], v[80:83], v[224:239]
    v_mfma_f32_32x32x16_bf16 v[240:255], v[172:175], v[84:87], v[240:255]
    buffer_load_dwordx4 v[168:171], v8, s[48:51], s80 offen offset:3072 sc1
    buffer_load_dwordx4 v[172:175], v8, s[48:51], s81 offen offset:3072 sc1
    s_waitcnt vmcnt(10)
    s_nop 0
    v_mfma_f32_32x32x16_bf16 v[192:207], v[128:131], v[88:91], v[192:207]
    v_mfma_f32_32x32x16_bf16 v[208:223], v[128:131], v[92:95], v[208:223]
    v_mfma_f32_32x32x16_bf16 v[224:239], v[132:135], v[88:91], v[224:239]
    v_mfma_f32_32x32x16_bf16 v[240:255], v[132:135], v[92:95], v[240:255]
    s_add_u32 s80, s79, 4096
    s_add_u32 s81, s80, 114688
    buffer_load_dwordx4 v[128:131], v8, s[48:51], s80 offen offset:0 sc1
    buffer_load_dwordx4 v[132:135], v8, s[48:51], s81 offen offset:0 sc1
    s_waitcnt vmcnt(10)
    s_nop 0
    ds_read_b64_tr_b16 v[176:177], v2 offset:16384
    ds_read_b64_tr_b16 v[178:179], v2 offset:17408
    ds_read_b64_tr_b16 v[180:181], v3 offset:16384
    ds_read_b64_tr_b16 v[182:183], v3 offset:17408
    v_mfma_f32_32x32x16_bf16 v[192:207], v[136:139], v[96:99], v[192:207]
    v_mfma_f32_32x32x16_bf16 v[208:223], v[136:139], v[100:103], v[208:223]
    v_mfma_f32_32x32x16_bf16 v[224:239], v[140:143], v[96:99], v[224:239]
    v_mfma_f32_32x32x16_bf16 v[240:255], v[140:143], v[100:103], v[240:255]
    buffer_load_dwordx4 v[136:139], v8, s[48:51], s80 offen offset:1024 sc1
    buffer_load_dwordx4 v[140:143], v8, s[48:51], s81 offen offset:1024 sc1
    s_waitcnt vmcnt(10)
    ds_read_b64_tr_b16 v[184:185], v2 offset:18432
    ds_read_b64_tr_b16 v[186:187], v2 offset:19456
    ds_read_b64_tr_b16 v[188:189], v3 offset:18432
    ds_read_b64_tr_b16 v[190:191], v3 offset:19456
    s_waitcnt lgkmcnt(4)
    v_mfma_f32_32x32x16_bf16 v[192:207], v[144:147], v[176:179], v[192:207]
    v_mfma_f32_32x32x16_bf16 v[208:223], v[144:147], v[180:183], v[208:223]
    v_mfma_f32_32x32x16_bf16 v[224:239], v[148:151], v[176:179], v[224:239]
    v_mfma_f32_32x32x16_bf16 v[240:255], v[148:151], v[180:183], v[240:255]
    buffer_load_dwordx4 v[144:147], v8, s[48:51], s80 offen offset:2048 sc1
    buffer_load_dwordx4 v[148:151], v8, s[48:51], s81 offen offset:2048 sc1
    s_waitcnt vmcnt(10)
    ds_read_b64_tr_b16 v[176:177], v4 offset:32768
    ds_read_b64_tr_b16 v[178:179], v4 offset:33792
    ds_read_b64_tr_b16 v[180:181], v5 offset:32768
    ds_read_b64_tr_b16 v[182:183], v5 offset:33792
    s_waitcnt lgkmcnt(4)
    v_mfma_f32_32x32x16_bf16 v[192:207], v[152:155], v[184:187], v[192:207]
    v_mfma_f32_32x32x16_bf16 v[208:223], v[152:155], v[188:191], v[208:223]
    v_mfma_f32_32x32x16_bf16 v[224:239], v[156:159], v[184:187], v[224:239]
    v_mfma_f32_32x32x16_bf16 v[240:255], v[156:159], v[188:191], v[240:255]
    buffer_load_dwordx4 v[152:155], v8, s[48:51], s80 offen offset:3072 sc1
    buffer_load_dwordx4 v[156:159], v8, s[48:51], s81 offen offset:3072 sc1
    s_waitcnt vmcnt(10)
    ds_read_b64_tr_b16 v[184:185], v4 offset:34816
    ds_read_b64_tr_b16 v[186:187], v4 offset:35840
    ds_read_b64_tr_b16 v[188:189], v5 offset:34816
    ds_read_b64_tr_b16 v[190:191], v5 offset:35840
    s_waitcnt lgkmcnt(4)
    v_mfma_f32_32x32x16_bf16 v[192:207], v[160:163], v[176:179], v[192:207]
    v_mfma_f32_32x32x16_bf16 v[208:223], v[160:163], v[180:183], v[208:223]
    v_mfma_f32_32x32x16_bf16 v[224:239], v[164:167], v[176:179], v[224:239]
    v_mfma_f32_32x32x16_bf16 v[240:255], v[164:167], v[180:183], v[240:255]
    s_add_u32 s80, s79, 8192
    s_add_u32 s81, s80, 114688
    buffer_load_dwordx4 v[160:163], v8, s[48:51], s80 offen offset:0 sc1
    buffer_load_dwordx4 v[164:167], v8, s[48:51], s81 offen offset:0 sc1
    s_waitcnt vmcnt(10)
    ds_read_b64_tr_b16 v[176:177], v4 offset:49152
    ds_read_b64_tr_b16 v[178:179], v4 offset:50176
    ds_read_b64_tr_b16 v[180:181], v5 offset:49152
    ds_read_b64_tr_b16 v[182:183], v5 offset:50176
    s_waitcnt lgkmcnt(4)
    v_mfma_f32_32x32x16_bf16 v[192:207], v[168:171], v[184:187], v[192:207]
    v_mfma_f32_32x32x16_bf16 v[208:223], v[168:171], v[188:191], v[208:223]
    v_mfma_f32_32x32x16_bf16 v[224:239], v[172:175], v[184:187], v[224:239]
    v_mfma_f32_32x32x16_bf16 v[240:255], v[172:175], v[188:191], v[240:255]
    buffer_load_dwordx4 v[168:171], v8, s[48:51], s80 offen offset:1024 sc1
    buffer_load_dwordx4 v[172:175], v8, s[48:51], s81 offen offset:1024 sc1
    s_waitcnt vmcnt(10)
    ds_read_b64_tr_b16 v[184:185], v4 offset:51200
    ds_read_b64_tr_b16 v[186:187], v4 offset:52224
    ds_read_b64_tr_b16 v[188:189], v5 offset:51200
    ds_read_b64_tr_b16 v[190:191], v5 offset:52224
    s_waitcnt lgkmcnt(4)
    v_mfma_f32_32x32x16_bf16 v[192:207], v[128:131], v[176:179], v[192:207]
    v_mfma_f32_32x32x16_bf16 v[208:223], v[128:131], v[180:183], v[208:223]
    v_mfma_f32_32x32x16_bf16 v[224:239], v[132:135], v[176:179], v[224:239]
    v_mfma_f32_32x32x16_bf16 v[240:255], v[132:135], v[180:183], v[240:255]
    buffer_load_dwordx4 v[128:131], v8, s[48:51], s80 offen offset:2048 sc1
    buffer_load_dwordx4 v[132:135], v8, s[48:51], s81 offen offset:2048 sc1
    s_waitcnt vmcnt(10)
    ds_read_b64_tr_b16 v[176:177], v2 offset:32768
    ds_read_b64_tr_b16 v[178:179], v2 offset:33792
    ds_read_b64_tr_b16 v[180:181], v3 offset:32768
    ds_read_b64_tr_b16 v[182:183], v3 offset:33792
    s_waitcnt lgkmcnt(4)
    v_mfma_f32_32x32x16_bf16 v[192:207], v[136:139], v[184:187], v[192:207]
    v_mfma_f32_32x32x16_bf16 v[208:223], v[136:139], v[188:191], v[208:223]
    v_mfma_f32_32x32x16_bf16 v[224:239], v[140:143], v[184:187], v[224:239]
    v_mfma_f32_32x32x16_bf16 v[240:255], v[140:143], v[188:191], v[240:255]
    buffer_load_dwordx4 v[136:139], v8, s[48:51], s80 offen offset:3072 sc1
    buffer_load_dwordx4 v[140:143], v8, s[48:51], s81 offen offset:3072 sc1
    s_waitcnt vmcnt(10)
    ds_read_b64_tr_b16 v[184:185], v2 offset:34816
    ds_read_b64_tr_b16 v[186:187], v2 offset:35840
    ds_read_b64_tr_b16 v[188:189], v3 offset:34816
    ds_read_b64_tr_b16 v[190:191], v3 offset:35840
    s_waitcnt lgkmcnt(4)
    v_mfma_f32_32x32x16_bf16 v[192:207], v[144:147], v[176:179], v[192:207]
    v_mfma_f32_32x32x16_bf16 v[208:223], v[144:147], v[180:183], v[208:223]
    v_mfma_f32_32x32x16_bf16 v[224:239], v[148:151], v[176:179], v[224:239]
    v_mfma_f32_32x32x16_bf16 v[240:255], v[148:151], v[180:183], v[240:255]
    s_add_u32 s80, s79, 12288
    s_add_u32 s81, s80, 114688
    buffer_load_dwordx4 v[144:147], v8, s[48:51], s80 offen offset:0 sc1
    buffer_load_dwordx4 v[148:151], v8, s[48:51], s81 offen offset:0 sc1
    s_waitcnt vmcnt(10)
    ds_read_b64_tr_b16 v[176:177], v4 offset:0
    ds_read_b64_tr_b16 v[178:179], v4 offset:1024
    ds_read_b64_tr_b16 v[180:181], v5 offset:0
    ds_read_b64_tr_b16 v[182:183], v5 offset:1024
    s_waitcnt lgkmcnt(4)
    v_mfma_f32_32x32x16_bf16 v[192:207], v[152:155], v[184:187], v[192:207]
    v_mfma_f32_32x32x16_bf16 v[208:223], v[152:155], v[188:191], v[208:223]
    v_mfma_f32_32x32x16_bf16 v[224:239], v[156:159], v[184:187], v[224:239]
    v_mfma_f32_32x32x16_bf16 v[240:255], v[156:159], v[188:191], v[240:255]
    buffer_load_dwordx4 v[152:155], v8, s[48:51], s80 offen offset:1024 sc1
    buffer_load_dwordx4 v[156:159], v8, s[48:51], s81 offen offset:1024 sc1
    s_waitcnt vmcnt(10)
    ds_read_b64_tr_b16 v[184:185], v4 offset:2048
    ds_read_b64_tr_b16 v[186:187], v4 offset:3072
    ds_read_b64_tr_b16 v[188:189], v5 offset:2048
    ds_read_b64_tr_b16 v[190:191], v5 offset:3072
    s_waitcnt lgkmcnt(4)
    v_mfma_f32_32x32x16_bf16 v[192:207], v[160:163], v[176:179], v[192:207]
    v_mfma_f32_32x32x16_bf16 v[208:223], v[160:163], v[180:183], v[208:223]
    v_mfma_f32_32x32x16_bf16 v[224:239], v[164:167], v[176:179], v[224:239]
    v_mfma_f32_32x32x16_bf16 v[240:255], v[164:167], v[180:183], v[240:255]
    s_waitcnt vmcnt(8)
    ds_read_b64_tr_b16 v[176:177], v4 offset:16384
    ds_read_b64_tr_b16 v[178:179], v4 offset:17408
    ds_read_b64_tr_b16 v[180:181], v5 offset:16384
    ds_read_b64_tr_b16 v[182:183], v5 offset:17408
    s_waitcnt lgkmcnt(4)
    v_mfma_f32_32x32x16_bf16 v[192:207], v[168:171], v[184:187], v[192:207]
    v_mfma_f32_32x32x16_bf16 v[208:223], v[168:171], v[188:191], v[208:223]
    v_mfma_f32_32x32x16_bf16 v[224:239], v[172:175], v[184:187], v[224:239]
    v_mfma_f32_32x32x16_bf16 v[240:255], v[172:175], v[188:191], v[240:255]
    s_waitcnt vmcnt(6)
    ds_read_b64_tr_b16 v[184:185], v4 offset:18432
    ds_read_b64_tr_b16 v[186:187], v4 offset:19456
    ds_read_b64_tr_b16 v[188:189], v5 offset:18432
    ds_read_b64_tr_b16 v[190:191], v5 offset:19456
    s_waitcnt lgkmcnt(4)
    v_mfma_f32_32x32x16_bf16 v[192:207], v[128:131], v[176:179], v[192:207]
    v_mfma_f32_32x32x16_bf16 v[208:223], v[128:131], v[180:183], v[208:223]
    v_mfma_f32_32x32x16_bf16 v[224:239], v[132:135], v[176:179], v[224:239]
    v_mfma_f32_32x32x16_bf16 v[240:255], v[132:135], v[180:183], v[240:255]
    s_waitcnt vmcnt(4)
    ds_read_b64_tr_b16 v[176:177], v2 offset:0
    ds_read_b64_tr_b16 v[178:179], v2 offset:1024
    ds_read_b64_tr_b16 v[180:181], v3 offset:0
    ds_read_b64_tr_b16 v[182:183], v3 offset:1024
    s_waitcnt lgkmcnt(4)
    v_mfma_f32_32x32x16_bf16 v[192:207], v[136:139], v[184:187], v[192:207]
    v_mfma_f32_32x32x16_bf16 v[208:223], v[136:139], v[188:191], v[208:223]
    v_mfma_f32_32x32x16_bf16 v[224:239], v[140:143], v[184:187], v[224:239]
    v_mfma_f32_32x32x16_bf16 v[240:255], v[140:143], v[188:191], v[240:255]
    s_waitcnt vmcnt(2)
    ds_read_b64_tr_b16 v[184:185], v2 offset:2048
    ds_read_b64_tr_b16 v[186:187], v2 offset:3072
    ds_read_b64_tr_b16 v[188:189], v3 offset:2048
    ds_read_b64_tr_b16 v[190:191], v3 offset:3072
    s_waitcnt lgkmcnt(4)
    v_mfma_f32_32x32x16_bf16 v[192:207], v[144:147], v[176:179], v[192:207]
    v_mfma_f32_32x32x16_bf16 v[208:223], v[144:147], v[180:183], v[208:223]
    v_mfma_f32_32x32x16_bf16 v[224:239], v[148:151], v[176:179], v[224:239]
    v_mfma_f32_32x32x16_bf16 v[240:255], v[148:151], v[180:183], v[240:255]
    s_waitcnt vmcnt(0)
    s_waitcnt lgkmcnt(0)
    v_mfma_f32_32x32x16_bf16 v[192:207], v[152:155], v[184:187], v[192:207]
    v_mfma_f32_32x32x16_bf16 v[208:223], v[152:155], v[188:191], v[208:223]
    v_mfma_f32_32x32x16_bf16 v[224:239], v[156:159], v[184:187], v[224:239]
    v_mfma_f32_32x32x16_bf16 v[240:255], v[156:159], v[188:191], v[240:255]
    s_add_u32 m0, s76, 49152
    s_nop 7
    s_nop 0
    ds_write_addtid_b32 v192 offset:0
    ds_write_addtid_b32 v193 offset:256
    ds_write_addtid_b32 v194 offset:512
    ds_write_addtid_b32 v195 offset:768
    ds_write_addtid_b32 v196 offset:1024
    ds_write_addtid_b32 v197 offset:1280
    ds_write_addtid_b32 v198 offset:1536
    ds_write_addtid_b32 v199 offset:1792
    ds_write_addtid_b32 v200 offset:2048
    ds_write_addtid_b32 v201 offset:2304
    ds_write_addtid_b32 v202 offset:2560
    ds_write_addtid_b32 v203 offset:2816
    ds_write_addtid_b32 v204 offset:3072
    ds_write_addtid_b32 v205 offset:3328
    ds_write_addtid_b32 v206 offset:3584
    ds_write_addtid_b32 v207 offset:3840
    ds_write_addtid_b32 v208 offset:16384
    ds_write_addtid_b32 v209 offset:16640
    ds_write_addtid_b32 v210 offset:16896
    ds_write_addtid_b32 v211 offset:17152
    ds_write_addtid_b32 v212 offset:17408
    ds_write_addtid_b32 v213 offset:17664
    ds_write_addtid_b32 v214 offset:17920
    ds_write_addtid_b32 v215 offset:18176
    ds_write_addtid_b32 v216 offset:18432
    ds_write_addtid_b32 v217 offset:18688
    ds_write_addtid_b32 v218 offset:18944
    ds_write_addtid_b32 v219 offset:19200
    ds_write_addtid_b32 v220 offset:19456
    ds_write_addtid_b32 v221 offset:19712
    ds_write_addtid_b32 v222 offset:19968
    ds_write_addtid_b32 v223 offset:20224
    ds_write_addtid_b32 v224 offset:32768
    ds_write_addtid_b32 v225 offset:33024
    ds_write_addtid_b32 v226 offset:33280
    ds_write_addtid_b32 v227 offset:33536
    ds_write_addtid_b32 v228 offset:33792
    ds_write_addtid_b32 v229 offset:34048
    ds_write_addtid_b32 v230 offset:34304
    ds_write_addtid_b32 v231 offset:34560
    ds_write_addtid_b32 v232 offset:34816
    ds_write_addtid_b32 v233 offset:35072
    ds_write_addtid_b32 v234 offset:35328
    ds_write_addtid_b32 v235 offset:35584
    ds_write_addtid_b32 v236 offset:35840
    ds_write_addtid_b32 v237 offset:36096
    ds_write_addtid_b32 v238 offset:36352
    ds_write_addtid_b32 v239 offset:36608
    ds_write_addtid_b32 v240 offset:49152
    ds_write_addtid_b32 v241 offset:49408
    ds_write_addtid_b32 v242 offset:49664
    ds_write_addtid_b32 v243 offset:49920
    ds_write_addtid_b32 v244 offset:50176
    ds_write_addtid_b32 v245 offset:50432
    ds_write_addtid_b32 v246 offset:50688
    ds_write_addtid_b32 v247 offset:50944
    ds_write_addtid_b32 v248 offset:51200
    ds_write_addtid_b32 v249 offset:51456
    ds_write_addtid_b32 v250 offset:51712
    ds_write_addtid_b32 v251 offset:51968
    ds_write_addtid_b32 v252 offset:52224
    ds_write_addtid_b32 v253 offset:52480
    ds_write_addtid_b32 v254 offset:52736
    ds_write_addtid_b32 v255 offset:52992
    s_waitcnt lgkmcnt(0)
    s_barrier
    s_branch L_fin
L_side:
    s_lshl_b32 s56, s59, 1
    s_add_u32 s56, s56, s60
    s_lshl_b32 s56, s56, 2
    s_add_u32 s56, s56, s53
    s_lshl_b32 s54, s56, 3
    s_add_u32 s54, s54, s3
    v_lshrrev_b32 v2, 3, v1
    v_and_b32 v3, 7, v1
    v_mul_u32_u24 v4, 896, v2
    v_lshl_add_u32 v4, v3, 4, v4
    s_mul_i32 s61, s54, 7168
    v_add_u32 v4, s61, v4
    s_waitcnt lgkmcnt(0)
    global_load_dwordx4 v[8:11], v4, s[4:5] offset:0
    global_load_dwordx4 v[12:15], v4, s[4:5] offset:128
    global_load_dwordx4 v[16:19], v4, s[4:5] offset:256
    global_load_dwordx4 v[20:23], v4, s[4:5] offset:384
    global_load_dwordx4 v[24:27], v4, s[4:5] offset:512
    global_load_dwordx4 v[28:31], v4, s[4:5] offset:640
    global_load_dwordx4 v[32:35], v4, s[4:5] offset:768
    s_mov_b32 s48, s30
    s_and_b32 s49, s31, 0xffff
    s_mov_b32 s50, 16777216
    s_mov_b32 s51, 0x20000
    s_mul_i32 s62, s53, 200704
    s_mul_i32 s63, s60, 802816
    v_min_u32 v111, 447, v0
    v_lshl_add_u32 v112, v111, 7, s62
    v_add_u32 v110, s63, v112
    s_sub_u32 s63, 602112, s63
    v_cmp_gt_u32 vcc, 224, v111
    v_add_u32 v111, s63, v112
    s_nop 0
    v_cndmask_b32 v112, v111, v110, vcc
    s_mul_i32 s62, s53, 401408
    v_min_u32 v110, 447, v0
    v_lshl_add_u32 v110, v110, 7, s62
    s_mov_b32 s62, 0x3f803f80
    v_mov_b32 v100, 0
    v_mov_b32 v101, 0
    s_waitcnt vmcnt(6)
    v_dot2c_f32_bf16 v100, s62, v8
    v_lshlrev_b32 v40, 16, v8
    v_and_b32 v41, 0xffff0000, v8
    v_dot2c_f32_bf16 v101, s62, v9
    v_lshlrev_b32 v42, 16, v9
    v_and_b32 v43, 0xffff0000, v9
    v_dot2c_f32_bf16 v100, s62, v10
    v_lshlrev_b32 v44, 16, v10
    v_and_b32 v45, 0xffff0000, v10
    v_dot2c_f32_bf16 v101, s62, v11
    v_lshlrev_b32 v46, 16, v11
    v_and_b32 v47, 0xffff0000, v11
    s_waitcnt vmcnt(5)
    v_dot2c_f32_bf16 v100, s62, v12
    v_lshlrev_b32 v48, 16, v12
    v_and_b32 v49, 0xffff0000, v12
    v_dot2c_f32_bf16 v101, s62, v13
    v_lshlrev_b32 v50, 16, v13
    v_and_b32 v51, 0xffff0000, v13
    v_dot2c_f32_bf16 v100, s62, v14
    v_lshlrev_b32 v52, 16, v14
    v_and_b32 v53, 0xffff0000, v14
    v_dot2c_f32_bf16 v101, s62, v15
    v_lshlrev_b32 v54, 16, v15
    v_and_b32 v55, 0xffff0000, v15
    s_waitcnt vmcnt(4)
    v_dot2c_f32_bf16 v100, s62, v16
    v_lshlrev_b32 v56, 16, v16
    v_and_b32 v57, 0xffff0000, v16
    v_dot2c_f32_bf16 v101, s62, v17
    v_lshlrev_b32 v58, 16, v17
    v_and_b32 v59, 0xffff0000, v17
    v_dot2c_f32_bf16 v100, s62, v18
    v_lshlrev_b32 v60, 16, v18
    v_and_b32 v61, 0xffff0000, v18
    v_dot2c_f32_bf16 v101, s62, v19
    v_lshlrev_b32 v62, 16, v19
    v_and_b32 v63, 0xffff0000, v19
    s_waitcnt vmcnt(3)
    v_dot2c_f32_bf16 v100, s62, v20
    v_lshlrev_b32 v64, 16, v20
    v_and_b32 v65, 0xffff0000, v20
    v_dot2c_f32_bf16 v101, s62, v21
    v_lshlrev_b32 v66, 16, v21
    v_and_b32 v67, 0xffff0000, v21
    v_dot2c_f32_bf16 v100, s62, v22
    v_lshlrev_b32 v68, 16, v22
    v_and_b32 v69, 0xffff0000, v22
    v_dot2c_f32_bf16 v101, s62, v23
    v_lshlrev_b32 v70, 16, v23
    v_and_b32 v71, 0xffff0000, v23
    s_waitcnt vmcnt(2)
    v_dot2c_f32_bf16 v100, s62, v24
    v_lshlrev_b32 v72, 16, v24
    v_and_b32 v73, 0xffff0000, v24
    v_dot2c_f32_bf16 v101, s62, v25
    v_lshlrev_b32 v74, 16, v25
    v_and_b32 v75, 0xffff0000, v25
    v_dot2c_f32_bf16 v100, s62, v26
    v_lshlrev_b32 v76, 16, v26
    v_and_b32 v77, 0xffff0000, v26
    v_dot2c_f32_bf16 v101, s62, v27
    v_lshlrev_b32 v78, 16, v27
    v_and_b32 v79, 0xffff0000, v27
    s_waitcnt vmcnt(1)
    v_dot2c_f32_bf16 v100, s62, v28
    v_lshlrev_b32 v80, 16, v28
    v_and_b32 v81, 0xffff0000, v28
    v_dot2c_f32_bf16 v101, s62, v29
    v_lshlrev_b32 v82, 16, v29
    v_and_b32 v83, 0xffff0000, v29
    v_dot2c_f32_bf16 v100, s62, v30
    v_lshlrev_b32 v84, 16, v30
    v_and_b32 v85, 0xffff0000, v30
    v_dot2c_f32_bf16 v101, s62, v31
    v_lshlrev_b32 v86, 16, v31
    v_and_b32 v87, 0xffff0000, v31
    s_waitcnt vmcnt(0)
    v_add_u32 v113, 0, v110
    global_load_dword v114, v113, s[24:25]
    v_dot2c_f32_bf16 v100, s62, v32
    v_lshlrev_b32 v88, 16, v32
    v_and_b32 v89, 0xffff0000, v32
    v_dot2c_f32_bf16 v101, s62, v33
    v_lshlrev_b32 v90, 16, v33
    v_and_b32 v91, 0xffff0000, v33
    v_dot2c_f32_bf16 v100, s62, v34
    v_lshlrev_b32 v92, 16, v34
    v_and_b32 v93, 0xffff0000, v34
    v_dot2c_f32_bf16 v101, s62, v35
    v_lshlrev_b32 v94, 16, v35
    v_and_b32 v95, 0xffff0000, v35
    s_nop 2
    v_add_f32 v100, v100, v101
    s_nop 1
    v_add_f32_dpp v100, v100, v100 quad_perm:[1,0,3,2] row_mask:0xf bank_mask:0xf
    s_nop 1
    v_add_f32_dpp v100, v100, v100 quad_perm:[2,3,0,1] row_mask:0xf bank_mask:0xf
    s_nop 1
    v_add_f32_dpp v100, v100, v100 row_half_mirror row_mask:0xf bank_mask:0xf
    v_mul_f32 v38, 0xbb124925, v100
    v_mov_b32 v39, v38
    v_pk_add_f32 v[40:41], v[40:41], v[38:39]
    v_pk_add_f32 v[42:43], v[42:43], v[38:39]
    v_pk_add_f32 v[44:45], v[44:45], v[38:39]
    v_pk_add_f32 v[46:47], v[46:47], v[38:39]
    v_pk_add_f32 v[48:49], v[48:49], v[38:39]
    v_pk_add_f32 v[50:51], v[50:51], v[38:39]
    v_pk_add_f32 v[52:53], v[52:53], v[38:39]
    v_pk_add_f32 v[54:55], v[54:55], v[38:39]
    v_pk_add_f32 v[56:57], v[56:57], v[38:39]
    v_pk_add_f32 v[58:59], v[58:59], v[38:39]
    v_pk_add_f32 v[60:61], v[60:61], v[38:39]
    v_pk_add_f32 v[62:63], v[62:63], v[38:39]
    v_pk_add_f32 v[64:65], v[64:65], v[38:39]
    v_pk_add_f32 v[66:67], v[66:67], v[38:39]
    v_pk_add_f32 v[68:69], v[68:69], v[38:39]
    v_pk_add_f32 v[70:71], v[70:71], v[38:39]
    v_pk_add_f32 v[72:73], v[72:73], v[38:39]
    v_pk_add_f32 v[74:75], v[74:75], v[38:39]
    v_pk_add_f32 v[76:77], v[76:77], v[38:39]
    v_pk_add_f32 v[78:79], v[78:79], v[38:39]
    v_pk_add_f32 v[80:81], v[80:81], v[38:39]
    v_pk_add_f32 v[82:83], v[82:83], v[38:39]
    v_pk_add_f32 v[84:85], v[84:85], v[38:39]
    v_pk_add_f32 v[86:87], v[86:87], v[38:39]
    v_pk_add_f32 v[88:89], v[88:89], v[38:39]
    v_pk_add_f32 v[90:91], v[90:91], v[38:39]
    v_pk_add_f32 v[92:93], v[92:93], v[38:39]
    v_pk_add_f32 v[94:95], v[94:95], v[38:39]
    v_pk_mul_f32 v[100:101], v[40:41], v[40:41]
    v_pk_mul_f32 v[102:103], v[42:43], v[42:43]
    v_pk_fma_f32 v[100:101], v[44:45], v[44:45], v[100:101]
    v_pk_fma_f32 v[102:103], v[46:47], v[46:47], v[102:103]
    v_pk_fma_f32 v[100:101], v[48:49], v[48:49], v[100:101]
    v_pk_fma_f32 v[102:103], v[50:51], v[50:51], v[102:103]
    v_pk_fma_f32 v[100:101], v[52:53], v[52:53], v[100:101]
    v_pk_fma_f32 v[102:103], v[54:55], v[54:55], v[102:103]
    v_pk_fma_f32 v[100:101], v[56:57], v[56:57], v[100:101]
    v_pk_fma_f32 v[102:103], v[58:59], v[58:59], v[102:103]
    v_pk_fma_f32 v[100:101], v[60:61], v[60:61], v[100:101]
    v_pk_fma_f32 v[102:103], v[62:63], v[62:63], v[102:103]
    v_pk_fma_f32 v[100:101], v[64:65], v[64:65], v[100:101]
    v_pk_fma_f32 v[102:103], v[66:67], v[66:67], v[102:103]
    v_pk_fma_f32 v[100:101], v[68:69], v[68:69], v[100:101]
    v_pk_fma_f32 v[102:103], v[70:71], v[70:71], v[102:103]
    v_pk_fma_f32 v[100:101], v[72:73], v[72:73], v[100:101]
    v_pk_fma_f32 v[102:103], v[74:75], v[74:75], v[102:103]
    v_pk_fma_f32 v[100:101], v[76:77], v[76:77], v[100:101]
    v_pk_fma_f32 v[102:103], v[78:79], v[78:79], v[102:103]
    v_pk_fma_f32 v[100:101], v[80:81], v[80:81], v[100:101]
    v_pk_fma_f32 v[102:103], v[82:83], v[82:83], v[102:103]
    v_pk_fma_f32 v[100:101], v[84:85], v[84:85], v[100:101]
    v_pk_fma_f32 v[102:103], v[86:87], v[86:87], v[102:103]
    v_pk_fma_f32 v[100:101], v[88:89], v[88:89], v[100:101]
    v_pk_fma_f32 v[102:103], v[90:91], v[90:91], v[102:103]
    v_pk_fma_f32 v[100:101], v[92:93], v[92:93], v[100:101]
    v_pk_fma_f32 v[102:103], v[94:95], v[94:95], v[102:103]
    v_pk_add_f32 v[100:101], v[100:101], v[102:103]
    s_nop 0
    v_add_f32 v100, v100, v101
    s_nop 1
    v_add_f32_dpp v100, v100, v100 quad_perm:[1,0,3,2] row_mask:0xf bank_mask:0xf
    s_nop 1
    v_add_f32_dpp v100, v100, v100 quad_perm:[2,3,0,1] row_mask:0xf bank_mask:0xf
    s_nop 1
    v_add_f32_dpp v100, v100, v100 row_half_mirror row_mask:0xf bank_mask:0xf
    v_mul_f32 v100, 0x3b124925, v100
    v_cvt_pk_bf16_f32 v36, v38, v38
    v_cvt_pk_bf16_f32 v100, v100, v100
    v_lshlrev_b32 v100, 16, v100
    v_add_f32 v100, 0x3727c5ac, v100
    v_cvt_pk_bf16_f32 v100, v100, v100
    v_lshlrev_b32 v100, 16, v100
    v_sqrt_f32 v100, v100
    v_lshlrev_b32 v102, 16, v36
    v_cvt_pk_bf16_f32 v100, v100, v100
    v_lshlrev_b32 v100, 16, v100
    v_rcp_f32 v37, v100
    v_sub_f32 v102, v102, v38
    v_mul_f32 v102, v102, v37
    v_mov_b32 v103, v102
    v_mov_b32 v100, v37
    v_mov_b32 v101, v37
    v_lshlrev_b32 v6, 3, v2
    s_lshl_b32 s62, s54, 6
    s_add_u32 s62, s62, 2097152
    s_mov_b32 exec_lo, 0x01010101
    s_mov_b32 exec_hi, 0x01010101
    buffer_store_dwordx2 v[36:37], v6, s[48:51], s62 offen sc1
    s_mov_b64 exec, -1
    v_mov_b32 v5, 0
    v_lshlrev_b32 v6, 2, v0
    s_lshl_b32 s62, s2, 11
    s_add_u32 s62, s62, 2228224
    buffer_store_dword v5, v6, s[48:51], s62 offen sc1
    s_mul_i32 s62, s3, 7680
    v_mul_u32_u24 v6, 960, v2
    v_lshl_add_u32 v6, v3, 4, v6
    v_add_u32 v6, s62, v6
    s_nop 0
    v_pk_fma_f32 v[40:41], v[40:41], v[100:101], v[102:103]
    v_pk_fma_f32 v[42:43], v[42:43], v[100:101], v[102:103]
    v_pk_fma_f32 v[44:45], v[44:45], v[100:101], v[102:103]
    v_pk_fma_f32 v[46:47], v[46:47], v[100:101], v[102:103]
    v_pk_fma_f32 v[48:49], v[48:49], v[100:101], v[102:103]
    v_pk_fma_f32 v[50:51], v[50:51], v[100:101], v[102:103]
    v_pk_fma_f32 v[52:53], v[52:53], v[100:101], v[102:103]
    v_pk_fma_f32 v[54:55], v[54:55], v[100:101], v[102:103]
    v_pk_fma_f32 v[56:57], v[56:57], v[100:101], v[102:103]
    v_pk_fma_f32 v[58:59], v[58:59], v[100:101], v[102:103]
    v_pk_fma_f32 v[60:61], v[60:61], v[100:101], v[102:103]
    v_pk_fma_f32 v[62:63], v[62:63], v[100:101], v[102:103]
    v_pk_fma_f32 v[64:65], v[64:65], v[100:101], v[102:103]
    v_pk_fma_f32 v[66:67], v[66:67], v[100:101], v[102:103]
    v_pk_fma_f32 v[68:69], v[68:69], v[100:101], v[102:103]
    v_pk_fma_f32 v[70:71], v[70:71], v[100:101], v[102:103]
    v_pk_fma_f32 v[72:73], v[72:73], v[100:101], v[102:103]
    v_pk_fma_f32 v[74:75], v[74:75], v[100:101], v[102:103]
    v_pk_fma_f32 v[76:77], v[76:77], v[100:101], v[102:103]
    v_pk_fma_f32 v[78:79], v[78:79], v[100:101], v[102:103]
    v_pk_fma_f32 v[80:81], v[80:81], v[100:101], v[102:103]
    v_pk_fma_f32 v[82:83], v[82:83], v[100:101], v[102:103]
    v_pk_fma_f32 v[84:85], v[84:85], v[100:101], v[102:103]
    v_pk_fma_f32 v[86:87], v[86:87], v[100:101], v[102:103]
    v_pk_fma_f32 v[88:89], v[88:89], v[100:101], v[102:103]
    v_pk_fma_f32 v[90:91], v[90:91], v[100:101], v[102:103]
    v_pk_fma_f32 v[92:93], v[92:93], v[100:101], v[102:103]
    v_pk_fma_f32 v[94:95], v[94:95], v[100:101], v[102:103]
    v_cvt_pk_bf16_f32 v8, v40, v41
    v_cvt_pk_bf16_f32 v9, v42, v43
    v_cvt_pk_bf16_f32 v10, v44, v45
    v_cvt_pk_bf16_f32 v11, v46, v47
    ds_write_b128 v6, v[8:11] offset:0
    v_cvt_pk_bf16_f32 v12, v48, v49
    v_cvt_pk_bf16_f32 v13, v50, v51
    v_cvt_pk_bf16_f32 v14, v52, v53
    v_cvt_pk_bf16_f32 v15, v54, v55
    ds_write_b128 v6, v[12:15] offset:128
    v_cvt_pk_bf16_f32 v16, v56, v57
    v_cvt_pk_bf16_f32 v17, v58, v59
    v_cvt_pk_bf16_f32 v18, v60, v61
    v_cvt_pk_bf16_f32 v19, v62, v63
    ds_write_b128 v6, v[16:19] offset:256
    v_cvt_pk_bf16_f32 v20, v64, v65
    v_cvt_pk_bf16_f32 v21, v66, v67
    v_cvt_pk_bf16_f32 v22, v68, v69
    v_cvt_pk_bf16_f32 v23, v70, v71
    ds_write_b128 v6, v[20:23] offset:384
    v_cvt_pk_bf16_f32 v24, v72, v73
    v_cvt_pk_bf16_f32 v25, v74, v75
    v_cvt_pk_bf16_f32 v26, v76, v77
    v_cvt_pk_bf16_f32 v27, v78, v79
    ds_write_b128 v6, v[24:27] offset:512
    v_cvt_pk_bf16_f32 v28, v80, v81
    v_cvt_pk_bf16_f32 v29, v82, v83
    v_cvt_pk_bf16_f32 v30, v84, v85
    v_cvt_pk_bf16_f32 v31, v86, v87
    ds_write_b128 v6, v[28:31] offset:640
    v_cvt_pk_bf16_f32 v32, v88, v89
    v_cvt_pk_bf16_f32 v33, v90, v91
    v_cvt_pk_bf16_f32 v34, v92, v93
    v_cvt_pk_bf16_f32 v35, v94, v95
    ds_write_b128 v6, v[32:35] offset:768
    v_bfe_u32 v6, v1, 2, 2
    v_mul_u32_u24 v6, 960, v6
    v_lshrrev_b32 v4, 4, v1
    v_lshl_add_u32 v6, v4, 5, v6
    v_and_b32 v4, 3, v1
    v_lshl_add_u32 v6, v4, 3, v6
    v_add_u32 v6, s62, v6
    s_nop 0
    ds_read_b64_tr_b16 v[40:41], v6 offset:0
    ds_read_b64_tr_b16 v[42:43], v6 offset:3840
    ds_read_b64_tr_b16 v[44:45], v6 offset:128
    ds_read_b64_tr_b16 v[46:47], v6 offset:3968
    ds_read_b64_tr_b16 v[48:49], v6 offset:256
    ds_read_b64_tr_b16 v[50:51], v6 offset:4096
    ds_read_b64_tr_b16 v[52:53], v6 offset:384
    ds_read_b64_tr_b16 v[54:55], v6 offset:4224
    ds_read_b64_tr_b16 v[56:57], v6 offset:512
    ds_read_b64_tr_b16 v[58:59], v6 offset:4352
    ds_read_b64_tr_b16 v[60:61], v6 offset:640
    ds_read_b64_tr_b16 v[62:63], v6 offset:4480
    ds_read_b64_tr_b16 v[64:65], v6 offset:768
    ds_read_b64_tr_b16 v[66:67], v6 offset:4608
    s_lshl_b32 s62, s3, 4
    s_add_u32 s62, s62, 65536
    v_mul_u32_u24 v6, 144, v1
    v_add_u32 v6, s62, v6
    s_waitcnt lgkmcnt(12)
    ds_write_b128 v6, v[40:43] offset:0
    s_waitcnt lgkmcnt(11)
    ds_write_b128 v6, v[44:47] offset:9216
    s_waitcnt lgkmcnt(10)
    ds_write_b128 v6, v[48:51] offset:18432
    s_waitcnt lgkmcnt(9)
    ds_write_b128 v6, v[52:55] offset:27648
    s_waitcnt lgkmcnt(8)
    ds_write_b128 v6, v[56:59] offset:36864
    s_waitcnt lgkmcnt(7)
    ds_write_b128 v6, v[60:63] offset:46080
    s_waitcnt lgkmcnt(6)
    ds_write_b128 v6, v[64:67] offset:55296
    s_mul_i32 s62, s3, 8064
    s_add_u32 s62, s62, 65536
    v_mul_u32_u24 v6, 144, v2
    v_lshl_add_u32 v6, v3, 4, v6
    v_add_u32 v6, s62, v6
    v_lshlrev_b32 v4, 12, v2
    v_lshl_add_u32 v4, v3, 4, v4
    s_mul_i32 s62, s3, 229376
    s_lshl_b32 s63, s56, 7
    s_add_u32 s62, s62, s63
    s_waitcnt lgkmcnt(0)
    s_barrier
    ds_read_b128 v[8:11], v6 offset:0
    ds_read_b128 v[12:15], v6 offset:1152
    ds_read_b128 v[16:19], v6 offset:2304
    ds_read_b128 v[20:23], v6 offset:3456
    ds_read_b128 v[24:27], v6 offset:4608
    ds_read_b128 v[28:31], v6 offset:5760
    ds_read_b128 v[32:35], v6 offset:6912
    s_waitcnt lgkmcnt(6)
    buffer_store_dwordx4 v[8:11], v4, s[48:51], s62 offen sc1
    s_add_u32 s62, s62, 32768
    s_waitcnt lgkmcnt(5)
    buffer_store_dwordx4 v[12:15], v4, s[48:51], s62 offen sc1
    s_add_u32 s62, s62, 32768
    s_waitcnt lgkmcnt(4)
    buffer_store_dwordx4 v[16:19], v4, s[48:51], s62 offen sc1
    s_add_u32 s62, s62, 32768
    s_waitcnt lgkmcnt(3)
    buffer_store_dwordx4 v[20:23], v4, s[48:51], s62 offen sc1
    s_add_u32 s62, s62, 32768
    s_waitcnt lgkmcnt(2)
    buffer_store_dwordx4 v[24:27], v4, s[48:51], s62 offen sc1
    s_add_u32 s62, s62, 32768
    s_waitcnt lgkmcnt(1)
    buffer_store_dwordx4 v[28:31], v4, s[48:51], s62 offen sc1
    s_add_u32 s62, s62, 32768
    s_waitcnt lgkmcnt(0)
    buffer_store_dwordx4 v[32:35], v4, s[48:51], s62 offen sc1
    s_waitcnt vmcnt(0)
    s_barrier
    s_cmp_lg_u32 s3, 0
    s_cbranch_scc1 L_nf20
    s_lshl_b32 s62, s2, 2
    v_mov_b32 v6, s62
    v_mov_b32 v5, 1
    s_mov_b64 exec, 1
    global_store_dword v6, v5, s[28:29] offset:128 sc1
    s_mov_b64 exec, -1
L_nf20:
    s_nop 0
    v_add_u32 v113, 57344, v110
    global_load_dword v115, v113, s[24:25]
    v_add_u32 v113, 114688, v110
    global_load_dword v116, v113, s[24:25]
    v_add_u32 v113, 172032, v110
    global_load_dword v117, v113, s[24:25]
    v_add_u32 v113, 229376, v110
    global_load_dword v118, v113, s[24:25]
    s_waitcnt vmcnt(0)
    s_endpgm
L_xw:
    s_waitcnt lgkmcnt(0)
    s_barrier
    s_cmp_eq_u32 s66, 1
    s_cbranch_scc1 L_ph21
    ds_read2st64_b32 v[16:17], v82 offset0:0 offset1:1
    ds_read2st64_b32 v[18:19], v82 offset0:2 offset1:3
    ds_read2st64_b32 v[20:21], v82 offset0:4 offset1:5
    ds_read2st64_b32 v[24:25], v82 offset0:32 offset1:33
    ds_read2st64_b32 v[26:27], v82 offset0:34 offset1:35
    ds_read2st64_b32 v[28:29], v82 offset0:36 offset1:37
    ds_read2st64_b32 v[32:33], v83 offset0:0 offset1:1
    ds_read2st64_b32 v[34:35], v83 offset0:2 offset1:3
    ds_read2st64_b32 v[36:37], v83 offset0:4 offset1:5
    s_waitcnt lgkmcnt(0)
    v_add_f32 v104, v104, v16
    v_add_f32 v105, v105, v17
    v_add_f32 v106, v106, v18
    v_add_f32 v107, v107, v19
    v_add_f32 v108, v108, v20
    v_add_f32 v109, v109, v21
    v_add_f32 v104, v104, v24
    v_add_f32 v105, v105, v25
    v_add_f32 v106, v106, v26
    v_add_f32 v107, v107, v27
    v_add_f32 v108, v108, v28
    v_add_f32 v109, v109, v29
    v_add_f32 v104, v104, v32
    v_add_f32 v105, v105, v33
    v_add_f32 v106, v106, v34
    v_add_f32 v107, v107, v35
    v_add_f32 v108, v108, v36
    v_add_f32 v109, v109, v37
    ds_write2_b32 v84, v104, v105 offset0:0 offset1:1
    ds_write2_b32 v84, v106, v107 offset0:2 offset1:3
    ds_write2_b32 v85, v108, v109 offset0:0 offset1:1
    s_branch L_pj22
L_ph21:
    ds_read2st64_b32 v[16:17], v82 offset0:6 offset1:7
    ds_read2st64_b32 v[18:19], v82 offset0:8 offset1:9
    ds_read_b32 v20, v82 offset:2560
    ds_read2st64_b32 v[24:25], v82 offset0:38 offset1:39
    ds_read2st64_b32 v[26:27], v82 offset0:40 offset1:41
    ds_read_b32 v28, v82 offset:10752
    ds_read2st64_b32 v[32:33], v83 offset0:6 offset1:7
    ds_read2st64_b32 v[34:35], v83 offset0:8 offset1:9
    ds_read_b32 v36, v83 offset:2560
    s_waitcnt lgkmcnt(0)
    v_add_f32 v110, v110, v16
    v_add_f32 v111, v111, v17
    v_add_f32 v112, v112, v18
    v_add_f32 v113, v113, v19
    v_add_f32 v114, v114, v20
    v_add_f32 v110, v110, v24
    v_add_f32 v111, v111, v25
    v_add_f32 v112, v112, v26
    v_add_f32 v113, v113, v27
    v_add_f32 v114, v114, v28
    v_add_f32 v110, v110, v32
    v_add_f32 v111, v111, v33
    v_add_f32 v112, v112, v34
    v_add_f32 v113, v113, v35
    v_add_f32 v114, v114, v36
    ds_write2_b32 v84, v110, v111 offset0:0 offset1:1
    ds_write2_b32 v85, v112, v113 offset0:0 offset1:32
    s_mov_b64 exec, 1
    ds_write_b32 v85, v114 offset:512
    s_mov_b64 exec, -1
L_pj22:
    s_barrier
    s_add_u32 m0, s69, 147456
    s_nop 0
    buffer_load_dwordx4 v200, s[36:39], s71 offen lds
    s_add_u32 m0, s69, 155648
    s_nop 0
    buffer_load_dwordx4 v200, s[40:43], s71 offen lds
    s_add_u32 m0, s69, 148480
    s_add_u32 s71, s71, 114688
    buffer_load_dwordx4 v200, s[36:39], s72 offen lds
    s_add_u32 m0, s69, 156672
    s_cmp_eq_u32 s71, 1605632
    buffer_load_dwordx4 v200, s[40:43], s72 offen lds
    s_cselect_b32 s71, 0, s71
    s_add_u32 s72, s71, 14336
    s_add_u32 m0, s69, 98304
    s_nop 0
    buffer_load_dwordx4 v200, s[36:39], s71 offen lds
    s_add_u32 m0, s69, 106496
    s_nop 0
    buffer_load_dwordx4 v200, s[40:43], s71 offen lds
    s_add_u32 m0, s69, 99328
    s_add_u32 s71, s71, 114688
    buffer_load_dwordx4 v200, s[36:39], s72 offen lds
    s_add_u32 m0, s69, 107520
    s_cmp_eq_u32 s71, 1605632
    buffer_load_dwordx4 v200, s[40:43], s72 offen lds
    s_cselect_b32 s71, 0, s71
    s_add_u32 s72, s71, 14336
    s_add_u32 m0, s70, 81920
    s_add_u32 s59, s73, 0
    buffer_load_dwordx4 v201, s[32:35], s59 offen lds
    s_add_u32 m0, s70, 86016
    s_add_u32 s59, s73, 28672
    buffer_load_dwordx4 v201, s[32:35], s59 offen lds
    s_waitcnt lgkmcnt(0)
    s_barrier
    s_add_u32 m0, s70, 90112
    s_add_u32 s59, s73, 57344
    buffer_load_dwordx4 v201, s[32:35], s59 offen lds
    s_add_u32 m0, s70, 94208
    s_add_u32 s59, s73, 86016
    buffer_load_dwordx4 v201, s[32:35], s59 offen lds
    s_add_u32 s73, s73, 128
    s_cmp_eq_u32 s73, 896
    s_cselect_b32 s73, 0, s73
    s_add_u32 m0, s69, 114688
    s_nop 0
    buffer_load_dwordx4 v200, s[36:39], s71 offen lds
    s_add_u32 m0, s69, 122880
    s_nop 0
    buffer_load_dwordx4 v200, s[40:43], s71 offen lds
    s_add_u32 m0, s69, 115712
    s_add_u32 s71, s71, 114688
    buffer_load_dwordx4 v200, s[36:39], s72 offen lds
    s_add_u32 m0, s69, 123904
    s_cmp_eq_u32 s71, 1605632
    buffer_load_dwordx4 v200, s[40:43], s72 offen lds
    s_cselect_b32 s71, 0, s71
    s_add_u32 s72, s71, 14336
    s_add_u32 m0, s70, 49152
    s_add_u32 s59, s73, 0
    buffer_load_dwordx4 v201, s[32:35], s59 offen lds
    s_add_u32 m0, s70, 53248
    s_add_u32 s59, s73, 28672
    buffer_load_dwordx4 v201, s[32:35], s59 offen lds
    s_cmp_eq_u32 s66, 1
    s_cbranch_scc1 L_ph23
    ds_read_b32 v16, v64
    ds_read_b32 v24, v72
    s_branch L_pj24
L_ph23:
    ds_read_b32 v16, v64
    ds_read_b32 v17, v65
    ds_read_b32 v18, v66
    ds_read_b32 v19, v67
    ds_read_b32 v20, v68
    ds_read_b32 v21, v69
    ds_read_b32 v22, v70
    ds_read_b32 v23, v71
    ds_read_b32 v24, v72
L_pj24:
    s_waitcnt vmcnt(14)
    s_barrier
    s_add_u32 m0, s69, 131072
    s_nop 0
    buffer_load_dwordx4 v200, s[36:39], s71 offen lds
    s_add_u32 m0, s69, 139264
    s_nop 0
    buffer_load_dwordx4 v200, s[40:43], s71 offen lds
    s_add_u32 m0, s69, 132096
    s_add_u32 s71, s71, 114688
    buffer_load_dwordx4 v200, s[36:39], s72 offen lds
    s_add_u32 m0, s69, 140288
    s_cmp_eq_u32 s71, 1605632
    buffer_load_dwordx4 v200, s[40:43], s72 offen lds
    s_cselect_b32 s71, 0, s71
    s_nop 0
    s_add_u32 s72, s71, 14336
    s_add_u32 m0, s70, 57344
    s_add_u32 s59, s73, 57344
    buffer_load_dwordx4 v201, s[32:35], s59 offen lds
    s_add_u32 m0, s70, 61440
    s_add_u32 s59, s73, 86016
    buffer_load_dwordx4 v201, s[32:35], s59 offen lds
    s_add_u32 s73, s73, 128
    s_cmp_eq_u32 s73, 896
    s_cselect_b32 s73, 0, s73
    s_cmp_eq_u32 s66, 1
    s_cbranch_scc1 L_ph25
    ds_read_b32 v32, v80
    s_branch L_pj26
L_ph25:
    ds_read_b32 v25, v73
    ds_read_b32 v26, v74
    ds_read_b32 v27, v75
    ds_read_b32 v28, v76
    ds_read_b32 v29, v77
    ds_read_b32 v30, v78
    ds_read_b32 v31, v79
    ds_read_b32 v32, v80
L_pj26:
    s_waitcnt vmcnt(12)
    s_barrier
    s_add_u32 m0, s69, 147456
    s_nop 0
    buffer_load_dwordx4 v200, s[36:39], s71 offen lds
    s_add_u32 m0, s69, 155648
    s_nop 0
    buffer_load_dwordx4 v200, s[40:43], s71 offen lds
    s_add_u32 m0, s69, 148480
    s_add_u32 s71, s71, 114688
    buffer_load_dwordx4 v200, s[36:39], s72 offen lds
    s_add_u32 m0, s69, 156672
    s_cmp_eq_u32 s71, 1605632
    buffer_load_dwordx4 v200, s[40:43], s72 offen lds
    s_cselect_b32 s71, 0, s71
    s_add_u32 s72, s71, 14336
    s_add_u32 m0, s70, 65536
    s_add_u32 s59, s73, 0
    buffer_load_dwordx4 v201, s[32:35], s59 offen lds
    s_add_u32 m0, s70, 69632
    s_add_u32 s59, s73, 28672
    buffer_load_dwordx4 v201, s[32:35], s59 offen lds
    s_cmp_eq_u32 s66, 1
    s_cbranch_scc1 L_ph27
    s_waitcnt lgkmcnt(0)
    s_nop 0
    v_cvt_pk_bf16_f32 v40, v16, v16
    v_cvt_pk_bf16_f32 v41, v16, v16
    v_cvt_pk_bf16_f32 v42, v24, v24
    v_cvt_pk_bf16_f32 v43, v24, v24
    v_cvt_pk_bf16_f32 v44, v24, v24
    v_cvt_pk_bf16_f32 v45, v24, v32
    v_cvt_pk_bf16_f32 v46, v32, v32
    v_cvt_pk_bf16_f32 v47, v32, v32
    v_cvt_pk_bf16_f32 v48, v16, v16
    v_cvt_pk_bf16_f32 v49, v16, v24
    v_cvt_pk_bf16_f32 v50, v24, v24
    v_cvt_pk_bf16_f32 v51, v24, v24
    v_cvt_pk_bf16_f32 v52, v24, v24
    v_cvt_pk_bf16_f32 v53, v32, v32
    v_cvt_pk_bf16_f32 v54, v32, v32
    v_cvt_pk_bf16_f32 v55, v32, v32
    s_branch L_pj28
L_ph27:
    s_waitcnt lgkmcnt(0)
    v_cvt_pk_bf16_f32 v40, v16, v17
    v_cvt_pk_bf16_f32 v41, v18, v19
    v_cvt_pk_bf16_f32 v42, v20, v21
    v_cvt_pk_bf16_f32 v43, v22, v23
    v_cvt_pk_bf16_f32 v44, v24, v25
    v_cvt_pk_bf16_f32 v45, v26, v27
    v_cvt_pk_bf16_f32 v46, v28, v29
    v_cvt_pk_bf16_f32 v47, v30, v31
    v_cvt_pk_bf16_f32 v48, v17, v18
    v_cvt_pk_bf16_f32 v49, v19, v20
    v_cvt_pk_bf16_f32 v50, v21, v22
    v_cvt_pk_bf16_f32 v51, v23, v24
    v_cvt_pk_bf16_f32 v52, v25, v26
    v_cvt_pk_bf16_f32 v53, v27, v28
    v_cvt_pk_bf16_f32 v54, v29, v30
    v_cvt_pk_bf16_f32 v55, v31, v32
L_pj28:
    s_lshl_b32 s59, s66, 11
    s_add_u32 s60, s59, s78
    v_lshl_add_u32 v22, v1, 5, s60
    v_mov_b32 v24, 0
    v_mov_b32 v25, 0
    v_mov_b32 v26, 0
    v_mov_b32 v27, 0
    s_mul_i32 s59, s66, 4160
    s_add_u32 s59, s59, s78
    v_and_b32 v23, 1, v1
    v_lshl_add_u32 v23, v23, 4, s59
    s_waitcnt vmcnt(14)
    s_barrier
    s_add_u32 m0, s69, 98304
    s_nop 0
    buffer_load_dwordx4 v200, s[36:39], s71 offen lds
    s_add_u32 m0, s69, 106496
    s_nop 0
    buffer_load_dwordx4 v200, s[40:43], s71 offen lds
    s_add_u32 m0, s69, 99328
    s_add_u32 s71, s71, 114688
    buffer_load_dwordx4 v200, s[36:39], s72 offen lds
    s_add_u32 m0, s69, 107520
    s_cmp_eq_u32 s71, 1605632
    buffer_load_dwordx4 v200, s[40:43], s72 offen lds
    s_cselect_b32 s71, 0, s71
    s_nop 0
    s_add_u32 s72, s71, 14336
    s_add_u32 m0, s70, 73728
    s_add_u32 s59, s73, 57344
    buffer_load_dwordx4 v201, s[32:35], s59 offen lds
    s_add_u32 m0, s70, 77824
    s_add_u32 s59, s73, 86016
    buffer_load_dwordx4 v201, s[32:35], s59 offen lds
    s_add_u32 s73, s73, 128
    s_cmp_eq_u32 s73, 896
    s_cselect_b32 s73, 0, s73
    s_waitcnt vmcnt(12)
    s_barrier
    s_add_u32 m0, s69, 114688
    s_nop 0
    buffer_load_dwordx4 v200, s[36:39], s71 offen lds
    s_add_u32 m0, s69, 122880
    s_nop 0
    buffer_load_dwordx4 v200, s[40:43], s71 offen lds
    s_add_u32 m0, s69, 115712
    s_add_u32 s71, s71, 114688
    buffer_load_dwordx4 v200, s[36:39], s72 offen lds
    s_add_u32 m0, s69, 123904
    s_cmp_eq_u32 s71, 1605632
    buffer_load_dwordx4 v200, s[40:43], s72 offen lds
    s_cselect_b32 s71, 0, s71
    s_add_u32 s72, s71, 14336
    s_add_u32 m0, s70, 81920
    s_add_u32 s59, s73, 0
    buffer_load_dwordx4 v201, s[32:35], s59 offen lds
    s_add_u32 m0, s70, 86016
    s_add_u32 s59, s73, 28672
    buffer_load_dwordx4 v201, s[32:35], s59 offen lds
    s_waitcnt vmcnt(14)
    s_barrier
    s_add_u32 m0, s69, 131072
    s_nop 0
    buffer_load_dwordx4 v200, s[36:39], s71 offen lds
    s_add_u32 m0, s69, 139264
    s_nop 0
    buffer_load_dwordx4 v200, s[40:43], s71 offen lds
    s_add_u32 m0, s69, 132096
    s_add_u32 s71, s71, 114688
    buffer_load_dwordx4 v200, s[36:39], s72 offen lds
    s_add_u32 m0, s69, 140288
    s_cmp_eq_u32 s71, 1605632
    buffer_load_dwordx4 v200, s[40:43], s72 offen lds
    s_cselect_b32 s71, 0, s71
    s_add_u32 s72, s71, 14336
    s_add_u32 m0, s70, 90112
    s_add_u32 s59, s73, 57344
    buffer_load_dwordx4 v201, s[32:35], s59 offen lds
    s_add_u32 m0, s70, 94208
    s_add_u32 s59, s73, 86016
    buffer_load_dwordx4 v201, s[32:35], s59 offen lds
    s_add_u32 s73, s73, 128
    s_cmp_eq_u32 s73, 896
    s_cselect_b32 s73, 0, s73
    v_and_b32 v9, 15, v1
    v_lshrrev_b32 v15, 4, v1
    v_sub_u32 v4, 2031, v9
    v_and_b32 v5, 1, v4
    v_mul_u32_u24 v5, 4160, v5
    v_lshrrev_b32 v4, 1, v4
    v_lshl_add_u32 v4, v4, 2, v5
    v_lshl_add_u32 v4, v15, 4, v4
    s_lshl_b32 s59, s66, 8
    s_sub_u32 s60, s78, s59
    v_add_u32 v4, s60, v4
    v_subrev_u32 v10, 704, v4
    v_subrev_u32 v11, 1728, v4
    v_subrev_u32 v12, 2752, v4
    v_subrev_u32 v13, 3776, v4
    s_sub_u32 s60, s67, s59
    s_add_u32 s60, s60, 256
    v_lshl_add_u32 v14, v9, 5, s60
    v_lshl_add_u32 v14, v15, 4, v14
    s_waitcnt vmcnt(12)
    s_barrier
    s_add_u32 m0, s69, 147456
    s_nop 0
    buffer_load_dwordx4 v200, s[36:39], s71 offen lds
    s_add_u32 m0, s69, 155648
    s_nop 0
    buffer_load_dwordx4 v200, s[40:43], s71 offen lds
    s_add_u32 m0, s69, 148480
    s_add_u32 s71, s71, 114688
    buffer_load_dwordx4 v200, s[36:39], s72 offen lds
    s_add_u32 m0, s69, 156672
    s_cmp_eq_u32 s71, 1605632
    buffer_load_dwordx4 v200, s[40:43], s72 offen lds
    s_cselect_b32 s71, 0, s71
    s_add_u32 s72, s71, 14336
    s_add_u32 m0, s70, 49152
    s_add_u32 s59, s73, 0
    buffer_load_dwordx4 v201, s[32:35], s59 offen lds
    s_add_u32 m0, s70, 53248
    s_add_u32 s59, s73, 28672
    buffer_load_dwordx4 v201, s[32:35], s59 offen lds
    v_bfe_u32 v2, v0, 3, 5
    v_and_b32 v2, 0x19, v2
    v_bfe_u32 v4, v0, 4, 1
    v_lshl_add_u32 v2, v4, 2, v2
    v_bfe_u32 v4, v0, 5, 1
    v_lshl_add_u32 v2, v4, 1, v2
    v_and_b32 v3, 7, v0
    v_mul_u32_u24 v254, 896, v2
    v_lshl_add_u32 v254, v3, 4, v254
    s_mul_i32 s60, s56, 57344
    s_lshl_b32 s61, s57, 7
    s_add_u32 s60, s60, s61
    v_add_u32 v254, s60, v254
    v_add_u32 v255, 28672, v254
    global_load_dwordx4 v[212:215], v254, s[4:5]
    global_load_dwordx4 v[216:219], v255, s[4:5]
    v_lshl_add_u32 v4, v3, 4, s61
    global_load_dwordx4 v[224:227], v4, s[16:17]
    v_lshrrev_b32 v4, 2, v3
    v_lshlrev_b32 v252, 14, v4
    v_lshrrev_b32 v4, 3, v2
    v_lshl_add_u32 v252, v4, 10, v252
    v_and_b32 v4, 3, v2
    v_lshl_add_u32 v252, v4, 8, v252
    v_bfe_u32 v4, v2, 2, 1
    v_lshl_add_u32 v252, v4, 7, v252
    v_and_b32 v4, 3, v3
    v_lshl_add_u32 v252, v4, 5, v252
    v_and_b32 v4, 1, v2
    v_lshl_add_u32 v252, v4, 4, v252
    v_add_u32 v252, 49152, v252
    v_xor_b32 v253, 16, v252
    s_waitcnt vmcnt(17)
    s_barrier
    s_add_u32 m0, s69, 98304
    s_nop 0
    buffer_load_dwordx4 v200, s[36:39], s71 offen lds
    s_add_u32 m0, s69, 106496
    s_nop 0
    buffer_load_dwordx4 v200, s[40:43], s71 offen lds
    s_add_u32 m0, s69, 99328
    s_add_u32 s71, s71, 114688
    buffer_load_dwordx4 v200, s[36:39], s72 offen lds
    s_add_u32 m0, s69, 107520
    s_cmp_eq_u32 s71, 1605632
    buffer_load_dwordx4 v200, s[40:43], s72 offen lds
    s_cselect_b32 s71, 0, s71
    s_add_u32 s72, s71, 14336
    s_add_u32 m0, s70, 57344
    s_add_u32 s59, s73, 57344
    buffer_load_dwordx4 v201, s[32:35], s59 offen lds
    s_add_u32 m0, s70, 61440
    s_add_u32 s59, s73, 86016
    buffer_load_dwordx4 v201, s[32:35], s59 offen lds
    s_add_u32 s73, s73, 128
    s_cmp_eq_u32 s73, 896
    s_cselect_b32 s73, 0, s73
    v_or_b32 v16, 32, v1
    v_lshlrev_b32 v16, 2, v16
    global_load_dword v17, v16, s[28:29] sc1
    s_waitcnt vmcnt(16)
    s_barrier
    s_add_u32 m0, s69, 114688
    s_nop 0
    buffer_load_dwordx4 v200, s[36:39], s71 offen lds
    s_add_u32 m0, s69, 122880
    s_nop 0
    buffer_load_dwordx4 v200, s[40:43], s71 offen lds
    s_add_u32 m0, s69, 115712
    s_add_u32 s71, s71, 114688
    buffer_load_dwordx4 v200, s[36:39], s72 offen lds
    s_add_u32 m0, s69, 123904
    s_cmp_eq_u32 s71, 1605632
    buffer_load_dwordx4 v200, s[40:43], s72 offen lds
    s_cselect_b32 s71, 0, s71
    s_add_u32 s72, s71, 14336
    s_add_u32 m0, s76, 65536
    s_add_u32 s74, s74, 7168
    buffer_load_dwordx4 v202, s[44:47], s74 offen lds
    s_add_u32 m0, s76, 66560
    s_add_u32 s74, s74, 7168
    buffer_load_dwordx4 v202, s[44:47], s74 offen lds
    s_add_u32 m0, s76, 67584
    s_add_u32 s74, s74, 7168
    buffer_load_dwordx4 v202, s[44:47], s74 offen lds
    s_add_u32 m0, s76, 68608
    s_add_u32 s74, s74, 7168
    buffer_load_dwordx4 v202, s[44:47], s74 offen lds
    s_waitcnt vmcnt(8)
    v_cmp_ne_u32 vcc, 0, v17
    s_nop 0
    s_cmp_eq_u64 vcc, exec
    s_cbranch_scc1 L_h129
    s_sleep 12
    s_mov_b32 s68, 0
L_pl30:
    global_load_dword v17, v16, s[28:29] sc1
L_pc32:
    s_waitcnt vmcnt(0)
    v_cmp_ne_u32 vcc, 0, v17
    s_add_u32 s68, s68, 1
    s_cmp_eq_u64 vcc, exec
    s_cbranch_scc1 L_pd31
    s_sleep 20
    s_cmp_lt_u32 s68, 65536
    s_cbranch_scc1 L_pl30
L_pd31:
L_h129:
    s_lshl_b32 s59, s66, 11
    s_lshl_b32 s60, s82, 12
    s_add_u32 s60, s60, s59
    v_lshlrev_b32 v4, 4, v1
    buffer_load_dwordx4 v[204:207], v4, s[48:51], s60 offen sc1
    buffer_load_dwordx4 v[208:211], v4, s[48:51], s60 offen offset:1024 sc1
    s_lshl_b32 s60, s56, 9
    s_add_u32 s60, s60, 2097152
    v_lshlrev_b32 v4, 3, v2
    buffer_load_dwordx2 v[220:221], v4, s[48:51], s60 offen sc1
    buffer_load_dwordx2 v[222:223], v4, s[48:51], s60 offen offset:256 sc1
    s_add_u32 s60, s59, s67
    v_lshl_add_u32 v5, v1, 4, s60
    s_waitcnt vmcnt(24)
    s_barrier
    s_nop 0
    s_add_u32 m0, s76, 131072
    s_add_u32 s74, s74, 7168
    buffer_load_dwordx4 v202, s[44:47], s74 offen lds
    s_add_u32 m0, s76, 132096
    s_add_u32 s74, s74, 7168
    buffer_load_dwordx4 v202, s[44:47], s74 offen lds
    s_add_u32 m0, s76, 133120
    s_add_u32 s74, s74, 7168
    buffer_load_dwordx4 v202, s[44:47], s74 offen lds
    s_add_u32 m0, s76, 134144
    s_add_u32 s74, s74, 7168
    buffer_load_dwordx4 v202, s[44:47], s74 offen lds
    s_waitcnt vmcnt(17)
    s_barrier
    s_add_u32 m0, s76, 147456
    s_add_u32 s74, s74, 7168
    buffer_load_dwordx4 v202, s[44:47], s74 offen lds
    s_add_u32 m0, s76, 148480
    s_add_u32 s74, s74, 7168
    buffer_load_dwordx4 v202, s[44:47], s74 offen lds
    s_add_u32 m0, s76, 149504
    s_add_u32 s74, s74, 7168
    buffer_load_dwordx4 v202, s[44:47], s74 offen lds
    s_add_u32 m0, s76, 150528
    s_add_u32 s74, s74, 7168
    buffer_load_dwordx4 v202, s[44:47], s74 offen lds
    s_add_u32 m0, s76, 81920
    s_add_u32 s74, s74, 7168
    buffer_load_dwordx4 v202, s[44:47], s74 offen lds
    s_add_u32 m0, s76, 82944
    s_add_u32 s74, s74, 7168
    buffer_load_dwordx4 v202, s[44:47], s74 offen lds
    s_add_u32 m0, s76, 83968
    s_add_u32 s74, s74, 7168
    buffer_load_dwordx4 v202, s[44:47], s74 offen lds
    s_add_u32 m0, s76, 84992
    s_add_u32 s74, s74, 7168
    buffer_load_dwordx4 v202, s[44:47], s74 offen lds
    s_waitcnt vmcnt(20)
    s_barrier
    s_add_u32 m0, s76, 98304
    s_add_u32 s74, s74, 7168
    buffer_load_dwordx4 v202, s[44:47], s74 offen lds
    s_add_u32 m0, s76, 99328
    s_add_u32 s74, s74, 7168
    buffer_load_dwordx4 v202, s[44:47], s74 offen lds
    s_add_u32 m0, s76, 100352
    s_add_u32 s74, s74, 7168
    buffer_load_dwordx4 v202, s[44:47], s74 offen lds
    s_add_u32 m0, s76, 101376
    s_add_u32 s74, s74, 7168
    buffer_load_dwordx4 v202, s[44:47], s74 offen lds
    s_min_u32 s59, s65, 1
    s_add_u32 s59, s59, 5
    s_and_b32 s60, s53, 3
    s_mul_i32 s60, s60, 7
    s_add_u32 s59, s59, s60
    s_mul_i32 s59, s59, 7
    s_add_u32 s59, s59, s57
    s_lshl_b32 s59, s59, 13
    v_lshl_add_u32 v6, v1, 7, s59
    s_cmp_lt_u32 s65, 2
    s_cselect_b64 exec, -1, 1
    global_load_dword v203, v6, s[24:25]
    s_mov_b64 exec, -1
    s_waitcnt vmcnt(13)
    s_barrier
    s_nop 0
    s_add_u32 m0, s76, 114688
    s_add_u32 s74, s74, 7168
    buffer_load_dwordx4 v202, s[44:47], s74 offen lds
    s_add_u32 m0, s76, 115712
    s_add_u32 s74, s74, 7168
    buffer_load_dwordx4 v202, s[44:47], s74 offen lds
    s_add_u32 m0, s76, 116736
    s_add_u32 s74, s74, 7168
    buffer_load_dwordx4 v202, s[44:47], s74 offen lds
    s_add_u32 m0, s76, 117760
    s_add_u32 s74, s74, 7168
    buffer_load_dwordx4 v202, s[44:47], s74 offen lds
    s_add_u32 m0, s76, 49152
    s_add_u32 s74, s74, 7168
    buffer_load_dwordx4 v202, s[44:47], s74 offen lds
    s_add_u32 m0, s76, 50176
    s_add_u32 s74, s74, 7168
    buffer_load_dwordx4 v202, s[44:47], s74 offen lds
    s_add_u32 m0, s76, 51200
    s_add_u32 s74, s74, 7168
    buffer_load_dwordx4 v202, s[44:47], s74 offen lds
    s_add_u32 m0, s76, 52224
    s_add_u32 s74, s74, 7168
    buffer_load_dwordx4 v202, s[44:47], s74 offen lds
    s_waitcnt vmcnt(25)
    ds_write_b128 v5, v[204:207] offset:480
    ds_write_b128 v5, v[208:211] offset:1504
    ds_write_b128 v22, v[40:43] offset:0
    ds_write_b128 v22, v[44:47] offset:16
    ds_write_b128 v22, v[48:51] offset:4160
    ds_write_b128 v22, v[52:55] offset:4176
    s_mov_b64 exec, 3
    ds_write_b128 v23, v[24:27] offset:4096
    s_mov_b64 exec, -1
    v_mov_b32 v4, 1
    ds_write_b32 v7, v4 offset:47824
    s_waitcnt vmcnt(9)
    v_mov_b32 v4, 1
    ds_write_b32 v7, v4 offset:47840
    s_mov_b32 s68, 0
L_sl33:
    ds_read_b32 v4, v8 offset:47824
    s_add_u32 s68, s68, 1
    s_waitcnt lgkmcnt(0)
    v_cmp_le_u32 vcc, 1, v4
    s_cbranch_vccnz L_sd34
    s_cmp_lt_u32 s68, 1048576
    s_cbranch_scc1 L_sl33
L_sd34:
    ds_read_b128 v[96:99], v14 offset:192
    ds_read2_b32 v[64:65], v10 offset0:176 offset1:177
    ds_read2_b32 v[66:67], v10 offset0:178 offset1:179
    ds_read_b128 v[100:103], v14 offset:704
    ds_read2_b32 v[68:69], v10 offset0:48 offset1:49
    ds_read2_b32 v[70:71], v10 offset0:50 offset1:51
    ds_read_b128 v[104:107], v14 offset:1216
    ds_read2_b32 v[72:73], v11 offset0:176 offset1:177
    ds_read2_b32 v[74:75], v11 offset0:178 offset1:179
    ds_read_b128 v[108:111], v14 offset:1728
    ds_read2_b32 v[76:77], v11 offset0:48 offset1:49
    ds_read2_b32 v[78:79], v11 offset0:50 offset1:51
    ds_read_b128 v[112:115], v14 offset:2240
    ds_read2_b32 v[80:81], v12 offset0:176 offset1:177
    ds_read2_b32 v[82:83], v12 offset0:178 offset1:179
    ds_read_b128 v[116:119], v14 offset:2752
    ds_read2_b32 v[84:85], v12 offset0:48 offset1:49
    ds_read2_b32 v[86:87], v12 offset0:50 offset1:51
    ds_read_b128 v[120:123], v14 offset:3264
    ds_read2_b32 v[88:89], v13 offset0:176 offset1:177
    ds_read2_b32 v[90:91], v13 offset0:178 offset1:179
    ds_read_b128 v[124:127], v14 offset:3776
    ds_read2_b32 v[92:93], v13 offset0:48 offset1:49
    ds_read2_b32 v[94:95], v13 offset0:50 offset1:51
    s_setprio 2
    s_waitcnt lgkmcnt(0)
    v_mfma_f32_16x16x32_bf16 v[32:35], v[64:67], v[96:99], 0
    ds_read_b128 v[160:163], v14 offset:128
    v_mfma_f32_16x16x32_bf16 v[36:39], v[64:67], v[100:103], 0
    ds_read2_b32 v[128:129], v10 offset0:160 offset1:161
    v_mfma_f32_16x16x32_bf16 v[40:43], v[64:67], v[104:107], 0
    ds_read2_b32 v[130:131], v10 offset0:162 offset1:163
    v_mfma_f32_16x16x32_bf16 v[44:47], v[64:67], v[108:111], 0
    ds_read_b128 v[164:167], v14 offset:640
    v_mfma_f32_16x16x32_bf16 v[48:51], v[64:67], v[112:115], 0
    ds_read2_b32 v[132:133], v10 offset0:32 offset1:33
    v_mfma_f32_16x16x32_bf16 v[52:55], v[64:67], v[116:119], 0
    ds_read2_b32 v[134:135], v10 offset0:34 offset1:35
    v_mfma_f32_16x16x32_bf16 v[56:59], v[64:67], v[120:123], 0
    ds_read_b128 v[168:171], v14 offset:1152
    v_mfma_f32_16x16x32_bf16 v[60:63], v[64:67], v[124:127], 0
    ds_read2_b32 v[136:137], v11 offset0:160 offset1:161
    v_mfma_f32_16x16x32_bf16 v[36:39], v[68:71], v[96:99], v[36:39]
    ds_read2_b32 v[138:139], v11 offset0:162 offset1:163
    v_mfma_f32_16x16x32_bf16 v[40:43], v[68:71], v[100:103], v[40:43]
    ds_read_b128 v[172:175], v14 offset:1664
    v_mfma_f32_16x16x32_bf16 v[44:47], v[68:71], v[104:107], v[44:47]
    ds_read2_b32 v[140:141], v11 offset0:32 offset1:33
    v_mfma_f32_16x16x32_bf16 v[48:51], v[68:71], v[108:111], v[48:51]
    ds_read2_b32 v[142:143], v11 offset0:34 offset1:35
    v_mfma_f32_16x16x32_bf16 v[52:55], v[68:71], v[112:115], v[52:55]
    ds_read_b128 v[176:179], v14 offset:2176
    v_mfma_f32_16x16x32_bf16 v[56:59], v[68:71], v[116:119], v[56:59]
    ds_read2_b32 v[144:145], v12 offset0:160 offset1:161
    v_mfma_f32_16x16x32_bf16 v[60:63], v[68:71], v[120:123], v[60:63]
    ds_read2_b32 v[146:147], v12 offset0:162 offset1:163
    v_mfma_f32_16x16x32_bf16 v[40:43], v[72:75], v[96:99], v[40:43]
    ds_read_b128 v[180:183], v14 offset:2688
    v_mfma_f32_16x16x32_bf16 v[44:47], v[72:75], v[100:103], v[44:47]
    ds_read2_b32 v[148:149], v12 offset0:32 offset1:33
    v_mfma_f32_16x16x32_bf16 v[48:51], v[72:75], v[104:107], v[48:51]
    ds_read2_b32 v[150:151], v12 offset0:34 offset1:35
    v_mfma_f32_16x16x32_bf16 v[52:55], v[72:75], v[108:111], v[52:55]
    ds_read_b128 v[184:187], v14 offset:3200
    v_mfma_f32_16x16x32_bf16 v[56:59], v[72:75], v[112:115], v[56:59]
    ds_read2_b32 v[152:153], v13 offset0:160 offset1:161
    v_mfma_f32_16x16x32_bf16 v[60:63], v[72:75], v[116:119], v[60:63]
    ds_read2_b32 v[154:155], v13 offset0:162 offset1:163
    v_mfma_f32_16x16x32_bf16 v[44:47], v[76:79], v[96:99], v[44:47]
    ds_read_b128 v[188:191], v14 offset:3712
    v_mfma_f32_16x16x32_bf16 v[48:51], v[76:79], v[100:103], v[48:51]
    ds_read2_b32 v[156:157], v13 offset0:32 offset1:33
    v_mfma_f32_16x16x32_bf16 v[52:55], v[76:79], v[104:107], v[52:55]
    ds_read2_b32 v[158:159], v13 offset0:34 offset1:35
    v_mfma_f32_16x16x32_bf16 v[56:59], v[76:79], v[108:111], v[56:59]
    v_mfma_f32_16x16x32_bf16 v[60:63], v[76:79], v[112:115], v[60:63]
    v_mfma_f32_16x16x32_bf16 v[48:51], v[80:83], v[96:99], v[48:51]
    v_mfma_f32_16x16x32_bf16 v[52:55], v[80:83], v[100:103], v[52:55]
    v_mfma_f32_16x16x32_bf16 v[56:59], v[80:83], v[104:107], v[56:59]
    v_mfma_f32_16x16x32_bf16 v[60:63], v[80:83], v[108:111], v[60:63]
    s_waitcnt vmcnt(0)
    v_mov_b32 v4, 2
    ds_write_b32 v7, v4 offset:47840
    v_mfma_f32_16x16x32_bf16 v[52:55], v[84:87], v[96:99], v[52:55]
    v_mfma_f32_16x16x32_bf16 v[56:59], v[84:87], v[100:103], v[56:59]
    v_mfma_f32_16x16x32_bf16 v[60:63], v[84:87], v[104:107], v[60:63]
    v_mfma_f32_16x16x32_bf16 v[56:59], v[88:91], v[96:99], v[56:59]
    v_mfma_f32_16x16x32_bf16 v[60:63], v[88:91], v[100:103], v[60:63]
    v_mfma_f32_16x16x32_bf16 v[60:63], v[92:95], v[96:99], v[60:63]
    s_waitcnt lgkmcnt(0)
    s_nop 0
    v_mfma_f32_16x16x32_bf16 v[32:35], v[128:131], v[160:163], v[32:35]
    ds_read_b128 v[96:99], v14 offset:64
    v_mfma_f32_16x16x32_bf16 v[36:39], v[128:131], v[164:167], v[36:39]
    ds_read2_b32 v[64:65], v10 offset0:144 offset1:145
    v_mfma_f32_16x16x32_bf16 v[40:43], v[128:131], v[168:171], v[40:43]
    ds_read2_b32 v[66:67], v10 offset0:146 offset1:147
    v_mfma_f32_16x16x32_bf16 v[44:47], v[128:131], v[172:175], v[44:47]
    ds_read_b128 v[100:103], v14 offset:576
    v_mfma_f32_16x16x32_bf16 v[48:51], v[128:131], v[176:179], v[48:51]
    ds_read2_b32 v[68:69], v10 offset0:16 offset1:17
    v_mfma_f32_16x16x32_bf16 v[52:55], v[128:131], v[180:183], v[52:55]
    ds_read2_b32 v[70:71], v10 offset0:18 offset1:19
    v_mfma_f32_16x16x32_bf16 v[56:59], v[128:131], v[184:187], v[56:59]
    ds_read_b128 v[104:107], v14 offset:1088
    v_mfma_f32_16x16x32_bf16 v[60:63], v[128:131], v[188:191], v[60:63]
    ds_read2_b32 v[72:73], v11 offset0:144 offset1:145
    v_mfma_f32_16x16x32_bf16 v[36:39], v[132:135], v[160:163], v[36:39]
    ds_read2_b32 v[74:75], v11 offset0:146 offset1:147
    v_mfma_f32_16x16x32_bf16 v[40:43], v[132:135], v[164:167], v[40:43]
    ds_read_b128 v[108:111], v14 offset:1600
    v_mfma_f32_16x16x32_bf16 v[44:47], v[132:135], v[168:171], v[44:47]
    ds_read2_b32 v[76:77], v11 offset0:16 offset1:17
    v_mfma_f32_16x16x32_bf16 v[48:51], v[132:135], v[172:175], v[48:51]
    ds_read2_b32 v[78:79], v11 offset0:18 offset1:19
    v_mfma_f32_16x16x32_bf16 v[52:55], v[132:135], v[176:179], v[52:55]
    ds_read_b128 v[112:115], v14 offset:2112
    v_mfma_f32_16x16x32_bf16 v[56:59], v[132:135], v[180:183], v[56:59]
    ds_read2_b32 v[80:81], v12 offset0:144 offset1:145
    v_mfma_f32_16x16x32_bf16 v[60:63], v[132:135], v[184:187], v[60:63]
    ds_read2_b32 v[82:83], v12 offset0:146 offset1:147
    v_mfma_f32_16x16x32_bf16 v[40:43], v[136:139], v[160:163], v[40:43]
    ds_read_b128 v[116:119], v14 offset:2624
    v_mfma_f32_16x16x32_bf16 v[44:47], v[136:139], v[164:167], v[44:47]
    ds_read2_b32 v[84:85], v12 offset0:16 offset1:17
    v_mfma_f32_16x16x32_bf16 v[48:51], v[136:139], v[168:171], v[48:51]
    ds_read2_b32 v[86:87], v12 offset0:18 offset1:19
    v_mfma_f32_16x16x32_bf16 v[52:55], v[136:139], v[172:175], v[52:55]
    ds_read_b128 v[120:123], v14 offset:3136
    v_mfma_f32_16x16x32_bf16 v[56:59], v[136:139], v[176:179], v[56:59]
    ds_read2_b32 v[88:89], v13 offset0:144 offset1:145
    v_mfma_f32_16x16x32_bf16 v[60:63], v[136:139], v[180:183], v[60:63]
    ds_read2_b32 v[90:91], v13 offset0:146 offset1:147
    v_mfma_f32_16x16x32_bf16 v[44:47], v[140:143], v[160:163], v[44:47]
    ds_read_b128 v[124:127], v14 offset:3648
    v_mfma_f32_16x16x32_bf16 v[48:51], v[140:143], v[164:167], v[48:51]
    ds_read2_b32 v[92:93], v13 offset0:16 offset1:17
    v_mfma_f32_16x16x32_bf16 v[52:55], v[140:143], v[168:171], v[52:55]
    ds_read2_b32 v[94:95], v13 offset0:18 offset1:19
    v_mfma_f32_16x16x32_bf16 v[56:59], v[140:143], v[172:175], v[56:59]
    v_mfma_f32_16x16x32_bf16 v[60:63], v[140:143], v[176:179], v[60:63]
    v_mfma_f32_16x16x32_bf16 v[48:51], v[144:147], v[160:163], v[48:51]
    v_mfma_f32_16x16x32_bf16 v[52:55], v[144:147], v[164:167], v[52:55]
    v_mfma_f32_16x16x32_bf16 v[56:59], v[144:147], v[168:171], v[56:59]
    v_mfma_f32_16x16x32_bf16 v[60:63], v[144:147], v[172:175], v[60:63]
    v_mfma_f32_16x16x32_bf16 v[52:55], v[148:151], v[160:163], v[52:55]
    v_mfma_f32_16x16x32_bf16 v[56:59], v[148:151], v[164:167], v[56:59]
    v_mfma_f32_16x16x32_bf16 v[60:63], v[148:151], v[168:171], v[60:63]
    v_mfma_f32_16x16x32_bf16 v[56:59], v[152:155], v[160:163], v[56:59]
    v_mfma_f32_16x16x32_bf16 v[60:63], v[152:155], v[164:167], v[60:63]
    v_mfma_f32_16x16x32_bf16 v[60:63], v[156:159], v[160:163], v[60:63]
    s_waitcnt lgkmcnt(0)
    s_nop 0
    v_mfma_f32_16x16x32_bf16 v[32:35], v[64:67], v[96:99], v[32:35]
    ds_read_b128 v[160:163], v14 offset:0
    v_mfma_f32_16x16x32_bf16 v[36:39], v[64:67], v[100:103], v[36:39]
    ds_read2_b32 v[128:129], v10 offset0:128 offset1:129
    v_mfma_f32_16x16x32_bf16 v[40:43], v[64:67], v[104:107], v[40:43]
    ds_read2_b32 v[130:131], v10 offset0:130 offset1:131
    v_mfma_f32_16x16x32_bf16 v[44:47], v[64:67], v[108:111], v[44:47]
    ds_read_b128 v[164:167], v14 offset:512
    v_mfma_f32_16x16x32_bf16 v[48:51], v[64:67], v[112:115], v[48:51]
    ds_read2_b32 v[132:133], v10 offset0:0 offset1:1
    v_mfma_f32_16x16x32_bf16 v[52:55], v[64:67], v[116:119], v[52:55]
    ds_read2_b32 v[134:135], v10 offset0:2 offset1:3
    v_mfma_f32_16x16x32_bf16 v[56:59], v[64:67], v[120:123], v[56:59]
    ds_read_b128 v[168:171], v14 offset:1024
    v_mfma_f32_16x16x32_bf16 v[60:63], v[64:67], v[124:127], v[60:63]
    ds_read2_b32 v[136:137], v11 offset0:128 offset1:129
    v_mfma_f32_16x16x32_bf16 v[36:39], v[68:71], v[96:99], v[36:39]
    ds_read2_b32 v[138:139], v11 offset0:130 offset1:131
    v_mfma_f32_16x16x32_bf16 v[40:43], v[68:71], v[100:103], v[40:43]
    ds_read_b128 v[172:175], v14 offset:1536
    v_mfma_f32_16x16x32_bf16 v[44:47], v[68:71], v[104:107], v[44:47]
    ds_read2_b32 v[140:141], v11 offset0:0 offset1:1
    v_mfma_f32_16x16x32_bf16 v[48:51], v[68:71], v[108:111], v[48:51]
    ds_read2_b32 v[142:143], v11 offset0:2 offset1:3
    v_mfma_f32_16x16x32_bf16 v[52:55], v[68:71], v[112:115], v[52:55]
    ds_read_b128 v[176:179], v14 offset:2048
    v_mfma_f32_16x16x32_bf16 v[56:59], v[68:71], v[116:119], v[56:59]
    ds_read2_b32 v[144:145], v12 offset0:128 offset1:129
    v_mfma_f32_16x16x32_bf16 v[60:63], v[68:71], v[120:123], v[60:63]
    ds_read2_b32 v[146:147], v12 offset0:130 offset1:131
    v_mfma_f32_16x16x32_bf16 v[40:43], v[72:75], v[96:99], v[40:43]
    ds_read_b128 v[180:183], v14 offset:2560
    v_mfma_f32_16x16x32_bf16 v[44:47], v[72:75], v[100:103], v[44:47]
    ds_read2_b32 v[148:149], v12 offset0:0 offset1:1
    v_mfma_f32_16x16x32_bf16 v[48:51], v[72:75], v[104:107], v[48:51]
    ds_read2_b32 v[150:151], v12 offset0:2 offset1:3
    v_mfma_f32_16x16x32_bf16 v[52:55], v[72:75], v[108:111], v[52:55]
    ds_read_b128 v[184:187], v14 offset:3072
    v_mfma_f32_16x16x32_bf16 v[56:59], v[72:75], v[112:115], v[56:59]
    ds_read2_b32 v[152:153], v13 offset0:128 offset1:129
    v_mfma_f32_16x16x32_bf16 v[60:63], v[72:75], v[116:119], v[60:63]
    ds_read2_b32 v[154:155], v13 offset0:130 offset1:131
    v_mfma_f32_16x16x32_bf16 v[44:47], v[76:79], v[96:99], v[44:47]
    ds_read_b128 v[188:191], v14 offset:3584
    v_mfma_f32_16x16x32_bf16 v[48:51], v[76:79], v[100:103], v[48:51]
    ds_read2_b32 v[156:157], v13 offset0:0 offset1:1
    v_mfma_f32_16x16x32_bf16 v[52:55], v[76:79], v[104:107], v[52:55]
    ds_read2_b32 v[158:159], v13 offset0:2 offset1:3
    v_mfma_f32_16x16x32_bf16 v[56:59], v[76:79], v[108:111], v[56:59]
    v_mfma_f32_16x16x32_bf16 v[60:63], v[76:79], v[112:115], v[60:63]
    v_mfma_f32_16x16x32_bf16 v[48:51], v[80:83], v[96:99], v[48:51]
    v_mfma_f32_16x16x32_bf16 v[52:55], v[80:83], v[100:103], v[52:55]
    v_mfma_f32_16x16x32_bf16 v[56:59], v[80:83], v[104:107], v[56:59]
    v_mfma_f32_16x16x32_bf16 v[60:63], v[80:83], v[108:111], v[60:63]
    v_mfma_f32_16x16x32_bf16 v[52:55], v[84:87], v[96:99], v[52:55]
    v_mfma_f32_16x16x32_bf16 v[56:59], v[84:87], v[100:103], v[56:59]
    v_mfma_f32_16x16x32_bf16 v[60:63], v[84:87], v[104:107], v[60:63]
    v_mfma_f32_16x16x32_bf16 v[56:59], v[88:91], v[96:99], v[56:59]
    v_mfma_f32_16x16x32_bf16 v[60:63], v[88:91], v[100:103], v[60:63]
    v_mfma_f32_16x16x32_bf16 v[60:63], v[92:95], v[96:99], v[60:63]
    s_waitcnt lgkmcnt(0)
    s_nop 0
    v_mfma_f32_16x16x32_bf16 v[32:35], v[128:131], v[160:163], v[32:35]
    v_mfma_f32_16x16x32_bf16 v[36:39], v[128:131], v[164:167], v[36:39]
    v_mfma_f32_16x16x32_bf16 v[40:43], v[128:131], v[168:171], v[40:43]
    v_mfma_f32_16x16x32_bf16 v[44:47], v[128:131], v[172:175], v[44:47]
    v_mfma_f32_16x16x32_bf16 v[48:51], v[128:131], v[176:179], v[48:51]
    v_mfma_f32_16x16x32_bf16 v[52:55], v[128:131], v[180:183], v[52:55]
    v_mfma_f32_16x16x32_bf16 v[56:59], v[128:131], v[184:187], v[56:59]
    v_mfma_f32_16x16x32_bf16 v[60:63], v[128:131], v[188:191], v[60:63]
    v_mfma_f32_16x16x32_bf16 v[36:39], v[132:135], v[160:163], v[36:39]
    v_mfma_f32_16x16x32_bf16 v[40:43], v[132:135], v[164:167], v[40:43]
    v_mfma_f32_16x16x32_bf16 v[44:47], v[132:135], v[168:171], v[44:47]
    v_mfma_f32_16x16x32_bf16 v[48:51], v[132:135], v[172:175], v[48:51]
    v_mfma_f32_16x16x32_bf16 v[52:55], v[132:135], v[176:179], v[52:55]
    v_mfma_f32_16x16x32_bf16 v[56:59], v[132:135], v[180:183], v[56:59]
    v_mfma_f32_16x16x32_bf16 v[60:63], v[132:135], v[184:187], v[60:63]
    v_mfma_f32_16x16x32_bf16 v[40:43], v[136:139], v[160:163], v[40:43]
    v_mfma_f32_16x16x32_bf16 v[44:47], v[136:139], v[164:167], v[44:47]
    v_mfma_f32_16x16x32_bf16 v[48:51], v[136:139], v[168:171], v[48:51]
    v_mfma_f32_16x16x32_bf16 v[52:55], v[136:139], v[172:175], v[52:55]
    v_mfma_f32_16x16x32_bf16 v[56:59], v[136:139], v[176:179], v[56:59]
    v_mfma_f32_16x16x32_bf16 v[60:63], v[136:139], v[180:183], v[60:63]
    v_mfma_f32_16x16x32_bf16 v[44:47], v[140:143], v[160:163], v[44:47]
    v_mfma_f32_16x16x32_bf16 v[48:51], v[140:143], v[164:167], v[48:51]
    v_mfma_f32_16x16x32_bf16 v[52:55], v[140:143], v[168:171], v[52:55]
    v_mfma_f32_16x16x32_bf16 v[56:59], v[140:143], v[172:175], v[56:59]
    v_mfma_f32_16x16x32_bf16 v[60:63], v[140:143], v[176:179], v[60:63]
    v_mfma_f32_16x16x32_bf16 v[48:51], v[144:147], v[160:163], v[48:51]
    v_mfma_f32_16x16x32_bf16 v[52:55], v[144:147], v[164:167], v[52:55]
    v_mfma_f32_16x16x32_bf16 v[56:59], v[144:147], v[168:171], v[56:59]
    v_mfma_f32_16x16x32_bf16 v[60:63], v[144:147], v[172:175], v[60:63]
    v_mfma_f32_16x16x32_bf16 v[52:55], v[148:151], v[160:163], v[52:55]
    v_mfma_f32_16x16x32_bf16 v[56:59], v[148:151], v[164:167], v[56:59]
    v_mfma_f32_16x16x32_bf16 v[60:63], v[148:151], v[168:171], v[60:63]
    v_mfma_f32_16x16x32_bf16 v[56:59], v[152:155], v[160:163], v[56:59]
    v_mfma_f32_16x16x32_bf16 v[60:63], v[152:155], v[164:167], v[60:63]
    v_mfma_f32_16x16x32_bf16 v[60:63], v[156:159], v[160:163], v[60:63]
    s_lshl_b32 s59, s66, 12
    s_add_u32 s59, s59, s78
    v_lshl_add_u32 v5, v1, 4, s59
    s_xor_b32 s60, s66, 1
    s_lshl_b32 s60, s60, 12
    s_add_u32 s60, s60, s78
    v_lshl_add_u32 v6, v1, 4, s60
    s_setprio 3
    s_cmp_eq_u32 s66, 1
    s_cbranch_scc1 L_ph35
    ds_write_b128 v5, v[48:51] offset:8320
    ds_write_b128 v5, v[52:55] offset:9344
    ds_write_b128 v5, v[56:59] offset:10368
    ds_write_b128 v5, v[60:63] offset:11392
    s_branch L_pj36
L_ph35:
    ds_write_b128 v5, v[32:35] offset:8320
    ds_write_b128 v5, v[36:39] offset:9344
    ds_write_b128 v5, v[40:43] offset:10368
    ds_write_b128 v5, v[44:47] offset:11392
    v_mov_b32 v32, v48
    v_mov_b32 v33, v49
    v_mov_b32 v34, v50
    v_mov_b32 v35, v51
    v_mov_b32 v36, v52
    v_mov_b32 v37, v53
    v_mov_b32 v38, v54
    v_mov_b32 v39, v55
    v_mov_b32 v40, v56
    v_mov_b32 v41, v57
    v_mov_b32 v42, v58
    v_mov_b32 v43, v59
    v_mov_b32 v44, v60
    v_mov_b32 v45, v61
    v_mov_b32 v46, v62
    v_mov_b32 v47, v63
L_pj36:
    v_mov_b32 v4, 2
    ds_write_b32 v7, v4 offset:47824
    s_mov_b32 s68, 0
L_sl37:
    ds_read_b32 v4, v8 offset:47824
    s_add_u32 s68, s68, 1
    s_waitcnt lgkmcnt(0)
    v_cmp_le_u32 vcc, 2, v4
    s_cbranch_vccnz L_sd38
    s_cmp_lt_u32 s68, 1048576
    s_cbranch_scc1 L_sl37
L_sd38:
    ds_read_b128 v[64:67], v6 offset:8320
    ds_read_b128 v[68:71], v6 offset:9344
    ds_read_b128 v[72:75], v6 offset:10368
    ds_read_b128 v[76:79], v6 offset:11392
    v_and_b32 v4, 1, v15
    v_lshlrev_b32 v4, 9, v4
    v_lshl_add_u32 v4, v9, 5, v4
    v_lshrrev_b32 v5, 1, v15
    v_lshl_add_u32 v4, v5, 4, v4
    s_lshl_b32 s59, s82, 12
    s_lshl_b32 s60, s66, 11
    s_add_u32 s59, s59, s60
    s_add_u32 s59, s59, 12582912
    s_waitcnt lgkmcnt(0)
    v_add_f32 v32, v32, v64
    v_add_f32 v33, v33, v65
    v_add_f32 v34, v34, v66
    v_add_f32 v35, v35, v67
    v_add_f32 v36, v36, v68
    v_add_f32 v37, v37, v69
    v_add_f32 v38, v38, v70
    v_add_f32 v39, v39, v71
    v_add_f32 v40, v40, v72
    v_add_f32 v41, v41, v73
    v_add_f32 v42, v42, v74
    v_add_f32 v43, v43, v75
    v_add_f32 v44, v44, v76
    v_add_f32 v45, v45, v77
    v_add_f32 v46, v46, v78
    v_add_f32 v47, v47, v79
    s_nop 0
    v_cvt_pk_bf16_f32 v100, v32, v33
    v_cvt_pk_bf16_f32 v101, v34, v35
    v_cvt_pk_bf16_f32 v102, v36, v37
    v_cvt_pk_bf16_f32 v103, v38, v39
    v_cvt_pk_bf16_f32 v104, v40, v41
    v_cvt_pk_bf16_f32 v105, v42, v43
    v_cvt_pk_bf16_f32 v106, v44, v45
    v_cvt_pk_bf16_f32 v107, v46, v47
    s_nop 1
    v_permlane16_swap_b32 v100, v102
    v_permlane16_swap_b32 v101, v103
    v_permlane16_swap_b32 v104, v106
    v_permlane16_swap_b32 v105, v107
    buffer_store_dwordx4 v[100:103], v4, s[48:51], s59 offen offset:0 sc1
    buffer_store_dwordx4 v[104:107], v4, s[48:51], s59 offen offset:1024 sc1
    v_lshlrev_b32 v244, 16, v224
    v_and_b32 v245, 0xffff0000, v224
    v_lshlrev_b32 v246, 16, v225
    v_and_b32 v247, 0xffff0000, v225
    v_lshlrev_b32 v248, 16, v226
    v_and_b32 v249, 0xffff0000, v226
    v_lshlrev_b32 v250, 16, v227
    v_and_b32 v251, 0xffff0000, v227
    v_lshlrev_b32 v220, 16, v220
    v_lshlrev_b32 v228, 16, v212
    v_and_b32 v229, 0xffff0000, v212
    v_lshlrev_b32 v230, 16, v213
    v_and_b32 v231, 0xffff0000, v213
    v_lshlrev_b32 v232, 16, v214
    v_and_b32 v233, 0xffff0000, v214
    v_lshlrev_b32 v234, 16, v215
    v_and_b32 v235, 0xffff0000, v215
    v_add_f32 v6, v228, v220
    v_mul_f32 v6, v6, v221
    v_fmac_f32 v228, v244, v6
    v_add_f32 v6, v229, v220
    v_mul_f32 v6, v6, v221
    v_fmac_f32 v229, v245, v6
    v_add_f32 v6, v230, v220
    v_mul_f32 v6, v6, v221
    v_fmac_f32 v230, v246, v6
    v_add_f32 v6, v231, v220
    v_mul_f32 v6, v6, v221
    v_fmac_f32 v231, v247, v6
    v_add_f32 v6, v232, v220
    v_mul_f32 v6, v6, v221
    v_fmac_f32 v232, v248, v6
    v_add_f32 v6, v233, v220
    v_mul_f32 v6, v6, v221
    v_fmac_f32 v233, v249, v6
    v_add_f32 v6, v234, v220
    v_mul_f32 v6, v6, v221
    v_fmac_f32 v234, v250, v6
    v_add_f32 v6, v235, v220
    v_mul_f32 v6, v6, v221
    v_fmac_f32 v235, v251, v6
    v_mul_f32 v221, v221, v221
    v_lshlrev_b32 v222, 16, v222
    v_lshlrev_b32 v236, 16, v216
    v_and_b32 v237, 0xffff0000, v216
    v_lshlrev_b32 v238, 16, v217
    v_and_b32 v239, 0xffff0000, v217
    v_lshlrev_b32 v240, 16, v218
    v_and_b32 v241, 0xffff0000, v218
    v_lshlrev_b32 v242, 16, v219
    v_and_b32 v243, 0xffff0000, v219
    v_add_f32 v6, v236, v222
    v_mul_f32 v6, v6, v223
    v_fmac_f32 v236, v244, v6
    v_add_f32 v6, v237, v222
    v_mul_f32 v6, v6, v223
    v_fmac_f32 v237, v245, v6
    v_add_f32 v6, v238, v222
    v_mul_f32 v6, v6, v223
    v_fmac_f32 v238, v246, v6
    v_add_f32 v6, v239, v222
    v_mul_f32 v6, v6, v223
    v_fmac_f32 v239, v247, v6
    v_add_f32 v6, v240, v222
    v_mul_f32 v6, v6, v223
    v_fmac_f32 v240, v248, v6
    v_add_f32 v6, v241, v222
    v_mul_f32 v6, v6, v223
    v_fmac_f32 v241, v249, v6
    v_add_f32 v6, v242, v222
    v_mul_f32 v6, v6, v223
    v_fmac_f32 v242, v250, v6
    v_add_f32 v6, v243, v222
    v_mul_f32 v6, v6, v223
    v_fmac_f32 v243, v251, v6
    v_mul_f32 v223, v223, v223
    s_lshr_b32 s59, s82, 4
    s_lshl_b32 s59, s59, 1
    s_add_u32 s59, s59, s66
    s_lshl_b32 s59, s59, 7
    s_add_u32 s59, s59, 2260992
    s_mov_b32 s60, 1
    s_waitcnt vmcnt(0)
    s_atomic_add s60, s[30:31], s59
    s_lshl_b32 s61, s57, 2
    s_add_u32 s61, s61, s65
    s_lshl_b32 s61, s61, 1
    s_lshr_b32 s62, s56, 4
    s_add_u32 s61, s61, s62
    s_lshl_b32 s61, s61, 7
    s_add_u32 s61, s61, 2260992
    s_waitcnt lgkmcnt(0)
    s_mov_b32 s68, 0
L_ql39:
    s_mov_b32 s62, 0
    s_atomic_add s62, s[30:31], s61 glc
L_qc41:
    s_waitcnt lgkmcnt(0)
    s_cmp_ge_u32 s62, 16
    s_cbranch_scc1 L_qd40
    s_add_u32 s68, s68, 1
    s_sleep 4
    s_cmp_lt_u32 s68, 65536
    s_cbranch_scc1 L_ql39
L_qd40:
    s_lshl_b32 s59, s57, 2
    s_add_u32 s59, s59, s65
    s_lshl_b32 s59, s59, 16
    s_lshl_b32 s60, s56, 7
    s_add_u32 s59, s59, s60
    s_add_u32 s59, s59, 12582912
    s_add_u32 s60, s59, 32768
    v_lshrrev_b32 v4, 3, v1
    v_lshlrev_b32 v4, 12, v4
    v_lshl_add_u32 v4, v3, 4, v4
    buffer_load_dwordx4 v[64:67], v4, s[48:51], s59 offen sc1
    buffer_load_dwordx4 v[68:71], v4, s[48:51], s60 offen sc1
    s_mul_i32 s59, s65, 2288
    s_add_u32 s59, s59, 33280
    v_lshl_add_u32 v4, v1, 4, s59
    v_lshrrev_b32 v5, 1, v3
    v_mul_u32_u24 v5, 2288, v5
    v_and_b32 v6, 1, v3
    v_mul_u32_u24 v6, 1040, v6
    v_add_u32 v5, v5, v6
    v_lshl_add_u32 v5, v2, 1, v5
    v_mov_b32 v72, 0
    v_mov_b32 v73, 0
    v_mov_b32 v74, 0
    v_mov_b32 v75, 0
    v_mov_b32 v76, 0
    v_mov_b32 v77, 0
    v_mov_b32 v78, 0
    v_mov_b32 v79, 0
    v_mov_b32 v80, 0
    v_mov_b32 v81, 0
    v_mov_b32 v82, 0
    v_mov_b32 v83, 0
    v_mov_b32 v84, 0
    v_mov_b32 v85, 0
    v_mov_b32 v86, 0
    v_mov_b32 v87, 0
    v_and_b32 v8, 3, v1
    v_lshlrev_b32 v8, 2, v8
    s_waitcnt vmcnt(0)
    ds_write_b128 v4, v[64:67]
    ds_write_b128 v4, v[68:71] offset:1040
    v_mov_b32 v4, 1
    ds_write_b32 v7, v4 offset:47872
    s_mov_b32 s68, 0
L_sl42:
    ds_read_b32 v4, v8 offset:47872
    s_add_u32 s68, s68, 1
    s_waitcnt lgkmcnt(0)
    v_cmp_gt_u32 vcc, 1, v4
    s_cbranch_vccz L_sd43
    s_sleep 1
    s_cmp_lt_u32 s68, 1048576
    s_cbranch_scc1 L_sl42
L_sd43:
    s_nop 0
    ds_read_u16_d16_hi v72, v5 offset:33280
    ds_read_u16_d16_hi v73, v5 offset:33408
    ds_read_u16_d16_hi v74, v5 offset:33536
    ds_read_u16_d16_hi v75, v5 offset:33664
    ds_read_u16_d16_hi v76, v5 offset:33792
    ds_read_u16_d16_hi v77, v5 offset:33920
    ds_read_u16_d16_hi v78, v5 offset:34048
    ds_read_u16_d16_hi v79, v5 offset:34176
    ds_read_u16_d16_hi v80, v5 offset:33344
    ds_read_u16_d16_hi v81, v5 offset:33472
    ds_read_u16_d16_hi v82, v5 offset:33600
    ds_read_u16_d16_hi v83, v5 offset:33728
    ds_read_u16_d16_hi v84, v5 offset:33856
    ds_read_u16_d16_hi v85, v5 offset:33984
    ds_read_u16_d16_hi v86, v5 offset:34112
    ds_read_u16_d16_hi v87, v5 offset:34240
    s_waitcnt lgkmcnt(0)
    v_add_f32 v228, v228, v72
    v_add_f32 v229, v229, v73
    v_add_f32 v230, v230, v74
    v_add_f32 v231, v231, v75
    v_add_f32 v232, v232, v76
    v_add_f32 v233, v233, v77
    v_add_f32 v234, v234, v78
    v_add_f32 v235, v235, v79
    v_add_f32 v236, v236, v80
    v_add_f32 v237, v237, v81
    v_add_f32 v238, v238, v82
    v_add_f32 v239, v239, v83
    v_add_f32 v240, v240, v84
    v_add_f32 v241, v241, v85
    v_add_f32 v242, v242, v86
    v_add_f32 v243, v243, v87
    s_mov_b32 s62, 0xff00ff00
    s_mov_b32 s63, 0xff00ff00
    s_mov_b64 exec, s[62:63]
    v_swap_b32 v228, v232
    v_swap_b32 v229, v233
    v_swap_b32 v230, v234
    v_swap_b32 v231, v235
    v_swap_b32 v236, v240
    v_swap_b32 v237, v241
    v_swap_b32 v238, v242
    v_swap_b32 v239, v243
    s_mov_b64 exec, -1
    s_barrier
    ds_read_b128 v[64:67], v252 offset:0
    ds_read_b128 v[68:71], v253 offset:0
    ds_read_b128 v[72:75], v252 offset:4096
    ds_read_b128 v[76:79], v253 offset:4096
    ds_read_b128 v[80:83], v252 offset:8192
    ds_read_b128 v[84:87], v253 offset:8192
    ds_read_b128 v[88:91], v252 offset:12288
    ds_read_b128 v[92:95], v253 offset:12288
    ds_read_b128 v[96:99], v252 offset:32768
    ds_read_b128 v[100:103], v253 offset:32768
    ds_read_b128 v[104:107], v252 offset:36864
    ds_read_b128 v[108:111], v253 offset:36864
    ds_read_b128 v[112:115], v252 offset:40960
    ds_read_b128 v[116:119], v253 offset:40960
    ds_read_b128 v[120:123], v252 offset:45056
    ds_read_b128 v[124:127], v253 offset:45056
    s_waitcnt lgkmcnt(12)
    v_pk_add_f32 v[64:65], v[64:65], v[72:73]
    v_pk_add_f32 v[66:67], v[66:67], v[74:75]
    v_pk_add_f32 v[68:69], v[68:69], v[76:77]
    v_pk_add_f32 v[70:71], v[70:71], v[78:79]
    s_waitcnt lgkmcnt(8)
    v_pk_add_f32 v[80:81], v[80:81], v[88:89]
    v_pk_add_f32 v[82:83], v[82:83], v[90:91]
    v_pk_add_f32 v[84:85], v[84:85], v[92:93]
    v_pk_add_f32 v[86:87], v[86:87], v[94:95]
    v_pk_add_f32 v[64:65], v[64:65], v[80:81]
    v_pk_add_f32 v[66:67], v[66:67], v[82:83]
    v_pk_add_f32 v[68:69], v[68:69], v[84:85]
    v_pk_add_f32 v[70:71], v[70:71], v[86:87]
    v_pk_fma_f32 v[64:65], v[64:65], v[220:221], v[228:229] op_sel:[0,1,0] op_sel_hi:[1,1,1]
    v_pk_fma_f32 v[66:67], v[66:67], v[220:221], v[230:231] op_sel:[0,1,0] op_sel_hi:[1,1,1]
    v_pk_fma_f32 v[68:69], v[68:69], v[220:221], v[232:233] op_sel:[0,1,0] op_sel_hi:[1,1,1]
    v_pk_fma_f32 v[70:71], v[70:71], v[220:221], v[234:235] op_sel:[0,1,0] op_sel_hi:[1,1,1]
    v_cvt_pk_bf16_f32 v72, v64, v65
    v_cvt_pk_bf16_f32 v73, v66, v67
    v_cvt_pk_bf16_f32 v74, v68, v69
    v_cvt_pk_bf16_f32 v75, v70, v71
    s_mov_b64 exec, s[62:63]
    v_swap_b32 v72, v74
    v_swap_b32 v73, v75
    s_mov_b64 exec, -1
    global_store_dwordx4 v254, v[72:75], s[26:27] nt
    s_waitcnt lgkmcnt(4)
    v_pk_add_f32 v[96:97], v[96:97], v[104:105]
    v_pk_add_f32 v[98:99], v[98:99], v[106:107]
    v_pk_add_f32 v[100:101], v[100:101], v[108:109]
    v_pk_add_f32 v[102:103], v[102:103], v[110:111]
    s_waitcnt lgkmcnt(0)
    v_pk_add_f32 v[112:113], v[112:113], v[120:121]
    v_pk_add_f32 v[114:115], v[114:115], v[122:123]
    v_pk_add_f32 v[116:117], v[116:117], v[124:125]
    v_pk_add_f32 v[118:119], v[118:119], v[126:127]
    v_pk_add_f32 v[96:97], v[96:97], v[112:113]
    v_pk_add_f32 v[98:99], v[98:99], v[114:115]
    v_pk_add_f32 v[100:101], v[100:101], v[116:117]
    v_pk_add_f32 v[102:103], v[102:103], v[118:119]
    v_pk_fma_f32 v[96:97], v[96:97], v[222:223], v[236:237] op_sel:[0,1,0] op_sel_hi:[1,1,1]
    v_pk_fma_f32 v[98:99], v[98:99], v[222:223], v[238:239] op_sel:[0,1,0] op_sel_hi:[1,1,1]
    v_pk_fma_f32 v[100:101], v[100:101], v[222:223], v[240:241] op_sel:[0,1,0] op_sel_hi:[1,1,1]
    v_pk_fma_f32 v[102:103], v[102:103], v[222:223], v[242:243] op_sel:[0,1,0] op_sel_hi:[1,1,1]
    v_cvt_pk_bf16_f32 v104, v96, v97
    v_cvt_pk_bf16_f32 v105, v98, v99
    v_cvt_pk_bf16_f32 v106, v100, v101
    v_cvt_pk_bf16_f32 v107, v102, v103
    s_mov_b64 exec, s[62:63]
    v_swap_b32 v104, v106
    v_swap_b32 v105, v107
    s_mov_b64 exec, -1
    global_store_dwordx4 v255, v[104:107], s[26:27] nt
L_fin:
L_end:
    s_endpgm
.section .rodata,"a"
.p2align 6
.amdhsa_kernel parallel_sum__ssm_conv_s4d__glu_gated_reglu__prompt_kernel
  .amdhsa_next_free_vgpr 256
  .amdhsa_next_free_sgpr 102
  .amdhsa_accum_offset 256
  .amdhsa_group_segment_fixed_size 0
  .amdhsa_kernarg_size 112
  .amdhsa_user_sgpr_count 2
  .amdhsa_user_sgpr_kernarg_segment_ptr 1
  .amdhsa_system_sgpr_workgroup_id_x 1
.end_amdhsa_kernel
```
